```python
import torch

def _softmax(x, axis=-1):
    return torch.softmax(x, dim=axis)
def _gelu(x):
    return torch.nn.functional.gelu(x, approximate="tanh")
def _silu(x):
    return torch.nn.functional.silu(x)
def _sigmoid(x):
    return torch.sigmoid(x)
def _layernorm(x, axis=-1, eps=1e-5):
    m = x.mean(dim=axis, keepdim=True)
    v = x.var(dim=axis, keepdim=True, unbiased=False)
    return (x - m) / torch.sqrt(v + eps)
def _scatter_add(tgt, idx, src, axis=0):
    return tgt.clone().index_add_(axis, idx, src)
def _segment_sum(src, seg, n):
    out = torch.zeros((n,) + src.shape[1:], dtype=src.dtype)
    return out.index_add_(0, seg, src)
def _pad(x, pw):
    flat = tuple(v for pair in reversed(pw) for v in pair)
    return torch.nn.functional.pad(x, flat)

kernel_name = 'standalone__self_sup_conv_stem_hubert__speech'

def setup_inputs():

    _w = (lambda a: (lambda t: t.to(torch.bfloat16) if t.is_floating_point() else t)(torch.as_tensor(a)))
    B, T, D, K = 2, 16000, 512, 5
    scale = (1.0 / (K * D)) ** 0.5
    return {
        "x": _w((lambda *s: torch.randn(*s, dtype=torch.bfloat16) * 0.05)(B, T, D)),
        "w": _w((lambda *s: torch.randn(*s, dtype=torch.bfloat16) * 0.05)(K, D, D) * scale),
        "b": _w((lambda *s: torch.randn(*s, dtype=torch.bfloat16) * 0.05)(D) * 0.1),
        "gamma": _w(torch.ones((D,), dtype=float)),
        "beta": _w(torch.zeros((D,), dtype=float)),
    }

def reference(x, w, b, gamma, beta):
    B, T, D = x.shape
    K = w.shape[0]
    s = 2
    L = (T - K) // s + 1
    y = torch.einsum('blc,cd->bld', x[:, 0 : s * L : s, :], w[0])
    for i in range(1, K):
        y = y + torch.einsum('blc,cd->bld', x[:, i : i + s * L : s, :], w[i])
    y = y + b[None, None, :]
    mu = y.mean(1, keepdims=True)
    var = ((y - mu) ** 2).mean(1, keepdims=True)
    yn = (y - mu) / torch.sqrt(var + 1e-5)
    yn = yn * gamma[None, None, :] + beta[None, None, :]
    return _gelu(yn)
```

```asm
; @launch grid=(256,1,1) block=(256,1,1) lds=155648
.amdgcn_target "amdgcn-amd-amdhsa--gfx950"
.text
.globl standalone__self_sup_conv_stem_hubert__speech_kernel
.p2align 8
.type standalone__self_sup_conv_stem_hubert__speech_kernel,@function
standalone__self_sup_conv_stem_hubert__speech_kernel:
    s_cmp_ge_u32 s2, 256
    s_cbranch_scc1 L_end
    s_load_dwordx16 s[64:79], s[0:1], 0
    s_and_b32 s50, s2, 7
    s_lshr_b32 s51, s2, 3
    s_and_b32 s44, s51, 3
    s_lshl_b32 s44, s44, 7
    s_lshr_b32 s51, s2, 5
    s_lshl_b32 s51, s51, 3
    s_add_u32 s51, s51, s50
    s_lshr_b32 s41, s51, 5
    s_and_b32 s42, s51, 31
    s_lshl_b32 s43, s42, 8
    v_lshrrev_b32 v2, 6, v0
    v_and_b32 v1, 63, v0
    v_readfirstlane_b32 s38, v2
    s_waitcnt lgkmcnt(0)
    s_and_b32 s39, s38, 1
    s_lshr_b32 s40, s38, 1
    s_mov_b32 s8, s64
    s_mov_b32 s9, s65
    s_mov_b32 s10, 32768000
    s_mov_b32 s11, 0x00020000
    s_mov_b32 s12, s66
    s_mov_b32 s13, s67
    s_mov_b32 s14, 2621440
    s_mov_b32 s15, 0x00020000
    s_mov_b32 s24, s68
    s_mov_b32 s25, s69
    s_mov_b32 s26, 1024
    s_mov_b32 s27, 0x00020000
    s_mov_b32 s28, s70
    s_mov_b32 s29, s71
    s_mov_b32 s30, 1024
    s_mov_b32 s31, 0x00020000
    s_mov_b32 s32, s72
    s_mov_b32 s33, s73
    s_mov_b32 s34, 1024
    s_mov_b32 s35, 0x00020000
    s_mov_b32 s16, s74
    s_mov_b32 s17, s75
    s_mov_b32 s18, 16379904
    s_mov_b32 s19, 0x00020000
    s_mov_b32 s20, s78
    s_mov_b32 s21, s79
    s_mov_b32 s22, 16777216
    s_mov_b32 s23, 0x00020000
    s_mov_b32 s36, s76
    s_mov_b32 s37, s77
    s_lshl_b32 s50, s40, 6
    s_add_u32 s50, s50, s44
    v_and_b32 v2, 31, v1
    v_add_u32 v2, s50, v2
    v_lshlrev_b32 v2, 1, v2
    buffer_load_ushort v82, v2, s[24:27], 0 offen
    buffer_load_ushort v83, v2, s[24:27], 0 offen offset:64
    v_lshrrev_b32 v3, 4, v1
    v_bfe_u32 v4, v1, 2, 2
    v_xor_b32 v4, v4, v3
    v_lshlrev_b32 v4, 6, v4
    v_lshl_add_u32 v4, v3, 10, v4
    v_and_b32 v5, 3, v1
    v_lshl_add_u32 v80, v5, 4, v4
    s_lshl_b32 s50, s39, 2
    v_add_u32 v4, s50, v3
    v_and_b32 v4, 7, v4
    v_and_b32 v5, 7, v1
    v_xor_b32 v5, v5, v4
    v_lshrrev_b32 v4, 3, v1
    v_lshlrev_b32 v4, 11, v4
    v_lshl_add_u32 v81, v5, 4, v4
    s_lshl_b32 s80, s38, 12
    s_lshl_b32 s81, s38, 10
    s_lshl_b32 s46, s38, 14
    s_lshl_b32 s50, s44, 1
    s_add_u32 s46, s46, s50
    s_mul_i32 s47, s41, 16384000
    s_lshl_b32 s50, s43, 11
    s_add_u32 s47, s47, s50
    s_lshl_b32 s50, s38, 14
    s_add_u32 s47, s47, s50
    s_cmp_eq_u32 s38, 0
    s_cselect_b32 s50, 0, 0x40000000
    s_add_u32 s49, s47, s50
    s_add_u32 m0, s80, 0
    s_add_u32 s50, s46, 0
    buffer_load_dwordx4 v80, s[12:15], s50 offen lds
    s_add_u32 m0, s80, 1024
    s_add_u32 s50, s46, 4096
    buffer_load_dwordx4 v80, s[12:15], s50 offen lds
    s_add_u32 m0, s80, 2048
    s_add_u32 s50, s46, 8192
    buffer_load_dwordx4 v80, s[12:15], s50 offen lds
    s_add_u32 m0, s80, 3072
    s_add_u32 s50, s46, 12288
    buffer_load_dwordx4 v80, s[12:15], s50 offen lds
    s_add_u32 m0, s80, 16384
    s_add_u32 s50, s46, 1048576
    buffer_load_dwordx4 v80, s[12:15], s50 offen lds
    s_add_u32 m0, s80, 17408
    s_add_u32 s50, s46, 1052672
    buffer_load_dwordx4 v80, s[12:15], s50 offen lds
    s_add_u32 m0, s80, 18432
    s_add_u32 s50, s46, 1056768
    buffer_load_dwordx4 v80, s[12:15], s50 offen lds
    s_add_u32 m0, s80, 19456
    s_add_u32 s50, s46, 1060864
    buffer_load_dwordx4 v80, s[12:15], s50 offen lds
    s_add_u32 m0, s80, 32768
    s_add_u32 s50, s46, 2097152
    buffer_load_dwordx4 v80, s[12:15], s50 offen lds
    s_add_u32 m0, s80, 33792
    s_add_u32 s50, s46, 2101248
    buffer_load_dwordx4 v80, s[12:15], s50 offen lds
    s_add_u32 m0, s80, 34816
    s_add_u32 s50, s46, 2105344
    buffer_load_dwordx4 v80, s[12:15], s50 offen lds
    s_add_u32 m0, s80, 35840
    s_add_u32 s50, s46, 2109440
    buffer_load_dwordx4 v80, s[12:15], s50 offen lds
    s_add_u32 m0, s81, 81920
    s_add_u32 s51, s47, 0
    buffer_load_dwordx4 v81, s[8:11], s51 offen lds
    s_add_u32 m0, s81, 86016
    s_add_u32 s51, s47, 65536
    buffer_load_dwordx4 v81, s[8:11], s51 offen lds
    s_add_u32 m0, s81, 90112
    s_add_u32 s51, s47, 131072
    buffer_load_dwordx4 v81, s[8:11], s51 offen lds
    s_add_u32 m0, s81, 94208
    s_add_u32 s51, s47, 196608
    buffer_load_dwordx4 v81, s[8:11], s51 offen lds
    s_add_u32 m0, s81, 98304
    s_add_u32 s51, s47, 262144
    buffer_load_dwordx4 v81, s[8:11], s51 offen lds
    s_add_u32 m0, s81, 102400
    s_add_u32 s51, s47, 327680
    buffer_load_dwordx4 v81, s[8:11], s51 offen lds
    s_add_u32 m0, s81, 106496
    s_add_u32 s51, s47, 393216
    buffer_load_dwordx4 v81, s[8:11], s51 offen lds
    s_add_u32 m0, s81, 110592
    s_add_u32 s51, s47, 458752
    buffer_load_dwordx4 v81, s[8:11], s51 offen lds
    s_add_u32 m0, s81, 114688
    s_add_u32 s51, s49, 524288
    buffer_load_dwordx4 v81, s[8:11], s51 offen lds
    s_add_u32 m0, s80, 49152
    s_add_u32 s50, s46, 524288
    buffer_load_dwordx4 v80, s[12:15], s50 offen lds
    s_add_u32 m0, s80, 50176
    s_add_u32 s50, s46, 528384
    buffer_load_dwordx4 v80, s[12:15], s50 offen lds
    s_add_u32 m0, s80, 51200
    s_add_u32 s50, s46, 532480
    buffer_load_dwordx4 v80, s[12:15], s50 offen lds
    s_add_u32 m0, s80, 52224
    s_add_u32 s50, s46, 536576
    buffer_load_dwordx4 v80, s[12:15], s50 offen lds
    s_add_u32 m0, s80, 65536
    s_add_u32 s50, s46, 1572864
    buffer_load_dwordx4 v80, s[12:15], s50 offen lds
    s_add_u32 m0, s80, 66560
    s_add_u32 s50, s46, 1576960
    buffer_load_dwordx4 v80, s[12:15], s50 offen lds
    s_add_u32 m0, s80, 67584
    s_add_u32 s50, s46, 1581056
    buffer_load_dwordx4 v80, s[12:15], s50 offen lds
    s_add_u32 m0, s80, 68608
    s_add_u32 s50, s46, 1585152
    buffer_load_dwordx4 v80, s[12:15], s50 offen lds
    s_add_u32 s46, s46, 65536
    s_add_u32 s47, s47, 128
    s_add_u32 s49, s49, 128
    s_lshl_b32 s50, s39, 7
    v_and_b32 v2, 31, v1
    v_lshrrev_b32 v3, 5, v1
    v_add_u32 v4, s50, v2
    v_bfe_u32 v5, v4, 1, 3
    v_xor_b32 v5, v5, v3
    v_lshlrev_b32 v5, 4, v5
    v_lshl_add_u32 v5, v4, 7, v5
    v_add_u32 v5, 81920, v5
    v_xor_b32 v64, 0, v5
    v_xor_b32 v65, 32, v5
    v_xor_b32 v66, 64, v5
    v_xor_b32 v67, 96, v5
    v_add_u32 v4, s50, v2
    v_add_u32 v4, 1, v4
    v_bfe_u32 v5, v4, 1, 3
    v_xor_b32 v5, v5, v3
    v_lshlrev_b32 v5, 4, v5
    v_lshl_add_u32 v5, v4, 7, v5
    v_add_u32 v5, 81920, v5
    v_xor_b32 v68, 0, v5
    v_xor_b32 v69, 32, v5
    v_xor_b32 v70, 64, v5
    v_xor_b32 v71, 96, v5
    v_add_u32 v4, s50, v2
    v_add_u32 v4, 2, v4
    v_bfe_u32 v5, v4, 1, 3
    v_xor_b32 v5, v5, v3
    v_lshlrev_b32 v5, 4, v5
    v_lshl_add_u32 v5, v4, 7, v5
    v_add_u32 v5, 81920, v5
    v_xor_b32 v72, 0, v5
    v_xor_b32 v73, 32, v5
    v_xor_b32 v74, 64, v5
    v_xor_b32 v75, 96, v5
    v_bfe_u32 v2, v1, 2, 2
    v_lshl_add_u32 v4, v3, 3, v2
    v_lshlrev_b32 v4, 8, v4
    v_bfe_u32 v5, v1, 4, 1
    v_lshl_add_u32 v4, v5, 5, v4
    v_and_b32 v5, 3, v1
    v_lshl_add_u32 v4, v5, 3, v4
    s_lshl_b32 s50, s40, 1
    s_add_u32 s50, s50, 0
    v_xor_b32 v5, s50, v2
    v_lshl_add_u32 v5, v5, 6, v4
    v_mov_b32 v76, v5
    v_add_u32 v77, 49152, v5
    s_lshl_b32 s50, s40, 1
    s_add_u32 s50, s50, 1
    v_xor_b32 v5, s50, v2
    v_lshl_add_u32 v5, v5, 6, v4
    v_mov_b32 v78, v5
    v_add_u32 v79, 49152, v5
    s_waitcnt vmcnt(29)
    v_lshlrev_b32 v82, 16, v82
    v_lshlrev_b32 v83, 16, v83
    v_mov_b32 v128, v82
    v_mov_b32 v129, v82
    v_mov_b32 v130, v82
    v_mov_b32 v131, v82
    v_mov_b32 v132, v82
    v_mov_b32 v133, v82
    v_mov_b32 v134, v82
    v_mov_b32 v135, v82
    v_mov_b32 v136, v82
    v_mov_b32 v137, v82
    v_mov_b32 v138, v82
    v_mov_b32 v139, v82
    v_mov_b32 v140, v82
    v_mov_b32 v141, v82
    v_mov_b32 v142, v82
    v_mov_b32 v143, v82
    v_mov_b32 v144, v83
    v_mov_b32 v145, v83
    v_mov_b32 v146, v83
    v_mov_b32 v147, v83
    v_mov_b32 v148, v83
    v_mov_b32 v149, v83
    v_mov_b32 v150, v83
    v_mov_b32 v151, v83
    v_mov_b32 v152, v83
    v_mov_b32 v153, v83
    v_mov_b32 v154, v83
    v_mov_b32 v155, v83
    v_mov_b32 v156, v83
    v_mov_b32 v157, v83
    v_mov_b32 v158, v83
    v_mov_b32 v159, v83
    v_mov_b32 v160, v82
    v_mov_b32 v161, v82
    v_mov_b32 v162, v82
    v_mov_b32 v163, v82
    v_mov_b32 v164, v82
    v_mov_b32 v165, v82
    v_mov_b32 v166, v82
    v_mov_b32 v167, v82
    v_mov_b32 v168, v82
    v_mov_b32 v169, v82
    v_mov_b32 v170, v82
    v_mov_b32 v171, v82
    v_mov_b32 v172, v82
    v_mov_b32 v173, v82
    v_mov_b32 v174, v82
    v_mov_b32 v175, v82
    v_mov_b32 v176, v83
    v_mov_b32 v177, v83
    v_mov_b32 v178, v83
    v_mov_b32 v179, v83
    v_mov_b32 v180, v83
    v_mov_b32 v181, v83
    v_mov_b32 v182, v83
    v_mov_b32 v183, v83
    v_mov_b32 v184, v83
    v_mov_b32 v185, v83
    v_mov_b32 v186, v83
    v_mov_b32 v187, v83
    v_mov_b32 v188, v83
    v_mov_b32 v189, v83
    v_mov_b32 v190, v83
    v_mov_b32 v191, v83
    v_mov_b32 v192, v82
    v_mov_b32 v193, v82
    v_mov_b32 v194, v82
    v_mov_b32 v195, v82
    v_mov_b32 v196, v82
    v_mov_b32 v197, v82
    v_mov_b32 v198, v82
    v_mov_b32 v199, v82
    v_mov_b32 v200, v82
    v_mov_b32 v201, v82
    v_mov_b32 v202, v82
    v_mov_b32 v203, v82
    v_mov_b32 v204, v82
    v_mov_b32 v205, v82
    v_mov_b32 v206, v82
    v_mov_b32 v207, v82
    v_mov_b32 v208, v83
    v_mov_b32 v209, v83
    v_mov_b32 v210, v83
    v_mov_b32 v211, v83
    v_mov_b32 v212, v83
    v_mov_b32 v213, v83
    v_mov_b32 v214, v83
    v_mov_b32 v215, v83
    v_mov_b32 v216, v83
    v_mov_b32 v217, v83
    v_mov_b32 v218, v83
    v_mov_b32 v219, v83
    v_mov_b32 v220, v83
    v_mov_b32 v221, v83
    v_mov_b32 v222, v83
    v_mov_b32 v223, v83
    v_mov_b32 v224, v82
    v_mov_b32 v225, v82
    v_mov_b32 v226, v82
    v_mov_b32 v227, v82
    v_mov_b32 v228, v82
    v_mov_b32 v229, v82
    v_mov_b32 v230, v82
    v_mov_b32 v231, v82
    v_mov_b32 v232, v82
    v_mov_b32 v233, v82
    v_mov_b32 v234, v82
    v_mov_b32 v235, v82
    v_mov_b32 v236, v82
    v_mov_b32 v237, v82
    v_mov_b32 v238, v82
    v_mov_b32 v239, v82
    v_mov_b32 v240, v83
    v_mov_b32 v241, v83
    v_mov_b32 v242, v83
    v_mov_b32 v243, v83
    v_mov_b32 v244, v83
    v_mov_b32 v245, v83
    v_mov_b32 v246, v83
    v_mov_b32 v247, v83
    v_mov_b32 v248, v83
    v_mov_b32 v249, v83
    v_mov_b32 v250, v83
    v_mov_b32 v251, v83
    v_mov_b32 v252, v83
    v_mov_b32 v253, v83
    v_mov_b32 v254, v83
    v_mov_b32 v255, v83
    s_waitcnt vmcnt(8)
    s_barrier
    ds_read_b128 v[16:19], v64 offset:0
    ds_read_b64_tr_b16 v[48:49], v76 offset:0
    ds_read_b64_tr_b16 v[50:51], v76 offset:1024
    ds_read_b64_tr_b16 v[52:53], v78 offset:0
    ds_read_b64_tr_b16 v[54:55], v78 offset:1024
    ds_read_b128 v[20:23], v64 offset:4096
    ds_read_b128 v[24:27], v64 offset:8192
    ds_read_b128 v[28:31], v64 offset:12288
    s_mov_b32 s45, 0
L_loop:
    s_waitcnt lgkmcnt(5)
    v_mfma_f32_32x32x16_bf16 v[128:143], v[16:19], v[48:51], v[128:143]
    ds_read_b128 v[32:35], v65 offset:0
    ds_read_b64_tr_b16 v[56:57], v76 offset:4096
    s_waitcnt lgkmcnt(5)
    v_mfma_f32_32x32x16_bf16 v[144:159], v[16:19], v[52:55], v[144:159]
    ds_read_b64_tr_b16 v[58:59], v76 offset:5120
    ds_read_b64_tr_b16 v[60:61], v78 offset:4096
    s_waitcnt lgkmcnt(6)
    v_mfma_f32_32x32x16_bf16 v[160:175], v[20:23], v[48:51], v[160:175]
    ds_read_b64_tr_b16 v[62:63], v78 offset:5120
    ds_read_b128 v[36:39], v65 offset:4096
    v_mfma_f32_32x32x16_bf16 v[176:191], v[20:23], v[52:55], v[176:191]
    ds_read_b128 v[40:43], v65 offset:8192
    ds_read_b128 v[44:47], v65 offset:12288
    s_waitcnt lgkmcnt(9)
    v_mfma_f32_32x32x16_bf16 v[192:207], v[24:27], v[48:51], v[192:207]
    s_add_u32 m0, s81, 118784
    s_add_u32 s51, s47, 896
    buffer_load_dwordx4 v81, s[8:11], s51 offen lds
    v_mfma_f32_32x32x16_bf16 v[208:223], v[24:27], v[52:55], v[208:223]
    s_add_u32 m0, s81, 122880
    s_add_u32 s51, s47, 66432
    buffer_load_dwordx4 v81, s[8:11], s51 offen lds
    s_waitcnt lgkmcnt(8)
    v_mfma_f32_32x32x16_bf16 v[224:239], v[28:31], v[48:51], v[224:239]
    s_add_u32 m0, s81, 126976
    s_add_u32 s51, s47, 131968
    buffer_load_dwordx4 v81, s[8:11], s51 offen lds
    v_mfma_f32_32x32x16_bf16 v[240:255], v[28:31], v[52:55], v[240:255]
    s_add_u32 m0, s81, 131072
    s_add_u32 s51, s47, 197504
    buffer_load_dwordx4 v81, s[8:11], s51 offen lds
    s_waitcnt lgkmcnt(5)
    v_mfma_f32_32x32x16_bf16 v[128:143], v[32:35], v[56:59], v[128:143]
    ds_read_b128 v[16:19], v66 offset:0
    ds_read_b64_tr_b16 v[48:49], v76 offset:8192
    s_waitcnt lgkmcnt(5)
    v_mfma_f32_32x32x16_bf16 v[144:159], v[32:35], v[60:63], v[144:159]
    ds_read_b64_tr_b16 v[50:51], v76 offset:9216
    ds_read_b64_tr_b16 v[52:53], v78 offset:8192
    s_waitcnt lgkmcnt(6)
    v_mfma_f32_32x32x16_bf16 v[160:175], v[36:39], v[56:59], v[160:175]
    ds_read_b64_tr_b16 v[54:55], v78 offset:9216
    ds_read_b128 v[20:23], v66 offset:4096
    v_mfma_f32_32x32x16_bf16 v[176:191], v[36:39], v[60:63], v[176:191]
    ds_read_b128 v[24:27], v66 offset:8192
    ds_read_b128 v[28:31], v66 offset:12288
    s_waitcnt lgkmcnt(9)
    v_mfma_f32_32x32x16_bf16 v[192:207], v[40:43], v[56:59], v[192:207]
    s_add_u32 m0, s81, 135168
    s_add_u32 s51, s47, 263040
    buffer_load_dwordx4 v81, s[8:11], s51 offen lds
    v_mfma_f32_32x32x16_bf16 v[208:223], v[40:43], v[60:63], v[208:223]
    s_add_u32 m0, s81, 139264
    s_add_u32 s51, s47, 328576
    buffer_load_dwordx4 v81, s[8:11], s51 offen lds
    s_waitcnt lgkmcnt(8)
    v_mfma_f32_32x32x16_bf16 v[224:239], v[44:47], v[56:59], v[224:239]
    s_add_u32 m0, s81, 143360
    s_add_u32 s51, s47, 394112
    buffer_load_dwordx4 v81, s[8:11], s51 offen lds
    v_mfma_f32_32x32x16_bf16 v[240:255], v[44:47], v[60:63], v[240:255]
    s_add_u32 m0, s81, 147456
    s_add_u32 s51, s47, 459648
    buffer_load_dwordx4 v81, s[8:11], s51 offen lds
    s_waitcnt lgkmcnt(5)
    v_mfma_f32_32x32x16_bf16 v[128:143], v[16:19], v[48:51], v[128:143]
    ds_read_b128 v[32:35], v67 offset:0
    ds_read_b64_tr_b16 v[56:57], v76 offset:12288
    s_waitcnt lgkmcnt(5)
    v_mfma_f32_32x32x16_bf16 v[144:159], v[16:19], v[52:55], v[144:159]
    ds_read_b64_tr_b16 v[58:59], v76 offset:13312
    ds_read_b64_tr_b16 v[60:61], v78 offset:12288
    s_waitcnt lgkmcnt(6)
    v_mfma_f32_32x32x16_bf16 v[160:175], v[20:23], v[48:51], v[160:175]
    ds_read_b64_tr_b16 v[62:63], v78 offset:13312
    ds_read_b128 v[36:39], v67 offset:4096
    v_mfma_f32_32x32x16_bf16 v[176:191], v[20:23], v[52:55], v[176:191]
    ds_read_b128 v[40:43], v67 offset:8192
    ds_read_b128 v[44:47], v67 offset:12288
    s_waitcnt lgkmcnt(9)
    v_mfma_f32_32x32x16_bf16 v[192:207], v[24:27], v[48:51], v[192:207]
    s_add_u32 m0, s81, 151552
    s_add_u32 s51, s49, 525184
    buffer_load_dwordx4 v81, s[8:11], s51 offen lds
    v_mfma_f32_32x32x16_bf16 v[208:223], v[24:27], v[52:55], v[208:223]
    s_waitcnt lgkmcnt(8)
    v_mfma_f32_32x32x16_bf16 v[224:239], v[28:31], v[48:51], v[224:239]
    v_mfma_f32_32x32x16_bf16 v[240:255], v[28:31], v[52:55], v[240:255]
    s_waitcnt lgkmcnt(5)
    v_mfma_f32_32x32x16_bf16 v[128:143], v[32:35], v[56:59], v[128:143]
    s_waitcnt vmcnt(30) lgkmcnt(0)
    s_barrier
    v_mfma_f32_32x32x16_bf16 v[144:159], v[32:35], v[60:63], v[144:159]
    ds_read_b128 v[16:19], v68 offset:0
    ds_read_b64_tr_b16 v[48:49], v76 offset:16384
    v_mfma_f32_32x32x16_bf16 v[160:175], v[36:39], v[56:59], v[160:175]
    ds_read_b64_tr_b16 v[50:51], v76 offset:17408
    ds_read_b64_tr_b16 v[52:53], v78 offset:16384
    v_mfma_f32_32x32x16_bf16 v[176:191], v[36:39], v[60:63], v[176:191]
    ds_read_b64_tr_b16 v[54:55], v78 offset:17408
    ds_read_b128 v[20:23], v68 offset:4096
    v_mfma_f32_32x32x16_bf16 v[192:207], v[40:43], v[56:59], v[192:207]
    ds_read_b128 v[24:27], v68 offset:8192
    ds_read_b128 v[28:31], v68 offset:12288
    v_mfma_f32_32x32x16_bf16 v[208:223], v[40:43], v[60:63], v[208:223]
    s_add_u32 m0, s80, 0
    s_add_u32 s50, s46, 0
    buffer_load_dwordx4 v80, s[12:15], s50 offen lds
    v_mfma_f32_32x32x16_bf16 v[224:239], v[44:47], v[56:59], v[224:239]
    s_add_u32 m0, s80, 1024
    s_add_u32 s50, s46, 4096
    buffer_load_dwordx4 v80, s[12:15], s50 offen lds
    v_mfma_f32_32x32x16_bf16 v[240:255], v[44:47], v[60:63], v[240:255]
    s_add_u32 m0, s80, 2048
    s_add_u32 s50, s46, 8192
    buffer_load_dwordx4 v80, s[12:15], s50 offen lds
    s_waitcnt lgkmcnt(5)
    v_mfma_f32_32x32x16_bf16 v[128:143], v[16:19], v[48:51], v[128:143]
    ds_read_b128 v[32:35], v69 offset:0
    ds_read_b64_tr_b16 v[56:57], v76 offset:20480
    s_waitcnt lgkmcnt(5)
    v_mfma_f32_32x32x16_bf16 v[144:159], v[16:19], v[52:55], v[144:159]
    ds_read_b64_tr_b16 v[58:59], v76 offset:21504
    ds_read_b64_tr_b16 v[60:61], v78 offset:20480
    s_waitcnt lgkmcnt(6)
    v_mfma_f32_32x32x16_bf16 v[160:175], v[20:23], v[48:51], v[160:175]
    ds_read_b64_tr_b16 v[62:63], v78 offset:21504
    ds_read_b128 v[36:39], v69 offset:4096
    v_mfma_f32_32x32x16_bf16 v[176:191], v[20:23], v[52:55], v[176:191]
    ds_read_b128 v[40:43], v69 offset:8192
    ds_read_b128 v[44:47], v69 offset:12288
    s_waitcnt lgkmcnt(9)
    v_mfma_f32_32x32x16_bf16 v[192:207], v[24:27], v[48:51], v[192:207]
    s_add_u32 m0, s80, 3072
    s_add_u32 s50, s46, 12288
    buffer_load_dwordx4 v80, s[12:15], s50 offen lds
    v_mfma_f32_32x32x16_bf16 v[208:223], v[24:27], v[52:55], v[208:223]
    s_waitcnt lgkmcnt(8)
    v_mfma_f32_32x32x16_bf16 v[224:239], v[28:31], v[48:51], v[224:239]
    v_mfma_f32_32x32x16_bf16 v[240:255], v[28:31], v[52:55], v[240:255]
    s_waitcnt lgkmcnt(5)
    v_mfma_f32_32x32x16_bf16 v[128:143], v[32:35], v[56:59], v[128:143]
    ds_read_b128 v[16:19], v70 offset:0
    ds_read_b64_tr_b16 v[48:49], v76 offset:24576
    s_waitcnt lgkmcnt(5)
    v_mfma_f32_32x32x16_bf16 v[144:159], v[32:35], v[60:63], v[144:159]
    ds_read_b64_tr_b16 v[50:51], v76 offset:25600
    ds_read_b64_tr_b16 v[52:53], v78 offset:24576
    s_waitcnt lgkmcnt(6)
    v_mfma_f32_32x32x16_bf16 v[160:175], v[36:39], v[56:59], v[160:175]
    ds_read_b64_tr_b16 v[54:55], v78 offset:25600
    ds_read_b128 v[20:23], v70 offset:4096
    v_mfma_f32_32x32x16_bf16 v[176:191], v[36:39], v[60:63], v[176:191]
    ds_read_b128 v[24:27], v70 offset:8192
    ds_read_b128 v[28:31], v70 offset:12288
    s_waitcnt lgkmcnt(9)
    v_mfma_f32_32x32x16_bf16 v[192:207], v[40:43], v[56:59], v[192:207]
    v_mfma_f32_32x32x16_bf16 v[208:223], v[40:43], v[60:63], v[208:223]
    s_waitcnt lgkmcnt(8)
    v_mfma_f32_32x32x16_bf16 v[224:239], v[44:47], v[56:59], v[224:239]
    v_mfma_f32_32x32x16_bf16 v[240:255], v[44:47], v[60:63], v[240:255]
    s_waitcnt lgkmcnt(5)
    v_mfma_f32_32x32x16_bf16 v[128:143], v[16:19], v[48:51], v[128:143]
    ds_read_b128 v[32:35], v71 offset:0
    ds_read_b64_tr_b16 v[56:57], v76 offset:28672
    s_waitcnt lgkmcnt(5)
    v_mfma_f32_32x32x16_bf16 v[144:159], v[16:19], v[52:55], v[144:159]
    ds_read_b64_tr_b16 v[58:59], v76 offset:29696
    ds_read_b64_tr_b16 v[60:61], v78 offset:28672
    s_waitcnt lgkmcnt(6)
    v_mfma_f32_32x32x16_bf16 v[160:175], v[20:23], v[48:51], v[160:175]
    ds_read_b64_tr_b16 v[62:63], v78 offset:29696
    ds_read_b128 v[36:39], v71 offset:4096
    v_mfma_f32_32x32x16_bf16 v[176:191], v[20:23], v[52:55], v[176:191]
    ds_read_b128 v[40:43], v71 offset:8192
    ds_read_b128 v[44:47], v71 offset:12288
    s_waitcnt lgkmcnt(9)
    v_mfma_f32_32x32x16_bf16 v[192:207], v[24:27], v[48:51], v[192:207]
    v_mfma_f32_32x32x16_bf16 v[208:223], v[24:27], v[52:55], v[208:223]
    s_waitcnt lgkmcnt(8)
    v_mfma_f32_32x32x16_bf16 v[224:239], v[28:31], v[48:51], v[224:239]
    v_mfma_f32_32x32x16_bf16 v[240:255], v[28:31], v[52:55], v[240:255]
    s_waitcnt lgkmcnt(5)
    v_mfma_f32_32x32x16_bf16 v[128:143], v[32:35], v[56:59], v[128:143]
    s_waitcnt vmcnt(30) lgkmcnt(0)
    s_barrier
    v_mfma_f32_32x32x16_bf16 v[144:159], v[32:35], v[60:63], v[144:159]
    ds_read_b128 v[16:19], v72 offset:0
    ds_read_b64_tr_b16 v[48:49], v76 offset:32768
    v_mfma_f32_32x32x16_bf16 v[160:175], v[36:39], v[56:59], v[160:175]
    ds_read_b64_tr_b16 v[50:51], v76 offset:33792
    ds_read_b64_tr_b16 v[52:53], v78 offset:32768
    v_mfma_f32_32x32x16_bf16 v[176:191], v[36:39], v[60:63], v[176:191]
    ds_read_b64_tr_b16 v[54:55], v78 offset:33792
    ds_read_b128 v[20:23], v72 offset:4096
    v_mfma_f32_32x32x16_bf16 v[192:207], v[40:43], v[56:59], v[192:207]
    ds_read_b128 v[24:27], v72 offset:8192
    ds_read_b128 v[28:31], v72 offset:12288
    v_mfma_f32_32x32x16_bf16 v[208:223], v[40:43], v[60:63], v[208:223]
    s_add_u32 m0, s80, 16384
    s_add_u32 s50, s46, 1048576
    buffer_load_dwordx4 v80, s[12:15], s50 offen lds
    v_mfma_f32_32x32x16_bf16 v[224:239], v[44:47], v[56:59], v[224:239]
    s_add_u32 m0, s80, 17408
    s_add_u32 s50, s46, 1052672
    buffer_load_dwordx4 v80, s[12:15], s50 offen lds
    v_mfma_f32_32x32x16_bf16 v[240:255], v[44:47], v[60:63], v[240:255]
    s_add_u32 m0, s80, 18432
    s_add_u32 s50, s46, 1056768
    buffer_load_dwordx4 v80, s[12:15], s50 offen lds
    s_waitcnt lgkmcnt(5)
    v_mfma_f32_32x32x16_bf16 v[128:143], v[16:19], v[48:51], v[128:143]
    ds_read_b128 v[32:35], v73 offset:0
    ds_read_b64_tr_b16 v[56:57], v76 offset:36864
    s_waitcnt lgkmcnt(5)
    v_mfma_f32_32x32x16_bf16 v[144:159], v[16:19], v[52:55], v[144:159]
    ds_read_b64_tr_b16 v[58:59], v76 offset:37888
    ds_read_b64_tr_b16 v[60:61], v78 offset:36864
    s_waitcnt lgkmcnt(6)
    v_mfma_f32_32x32x16_bf16 v[160:175], v[20:23], v[48:51], v[160:175]
    ds_read_b64_tr_b16 v[62:63], v78 offset:37888
    ds_read_b128 v[36:39], v73 offset:4096
    v_mfma_f32_32x32x16_bf16 v[176:191], v[20:23], v[52:55], v[176:191]
    ds_read_b128 v[40:43], v73 offset:8192
    ds_read_b128 v[44:47], v73 offset:12288
    s_waitcnt lgkmcnt(9)
    v_mfma_f32_32x32x16_bf16 v[192:207], v[24:27], v[48:51], v[192:207]
    s_add_u32 m0, s80, 19456
    s_add_u32 s50, s46, 1060864
    buffer_load_dwordx4 v80, s[12:15], s50 offen lds
    v_mfma_f32_32x32x16_bf16 v[208:223], v[24:27], v[52:55], v[208:223]
    s_waitcnt lgkmcnt(8)
    v_mfma_f32_32x32x16_bf16 v[224:239], v[28:31], v[48:51], v[224:239]
    v_mfma_f32_32x32x16_bf16 v[240:255], v[28:31], v[52:55], v[240:255]
    s_waitcnt lgkmcnt(5)
    v_mfma_f32_32x32x16_bf16 v[128:143], v[32:35], v[56:59], v[128:143]
    ds_read_b128 v[16:19], v74 offset:0
    ds_read_b64_tr_b16 v[48:49], v76 offset:40960
    s_waitcnt lgkmcnt(5)
    v_mfma_f32_32x32x16_bf16 v[144:159], v[32:35], v[60:63], v[144:159]
    ds_read_b64_tr_b16 v[50:51], v76 offset:41984
    ds_read_b64_tr_b16 v[52:53], v78 offset:40960
    s_waitcnt lgkmcnt(6)
    v_mfma_f32_32x32x16_bf16 v[160:175], v[36:39], v[56:59], v[160:175]
    ds_read_b64_tr_b16 v[54:55], v78 offset:41984
    ds_read_b128 v[20:23], v74 offset:4096
    v_mfma_f32_32x32x16_bf16 v[176:191], v[36:39], v[60:63], v[176:191]
    ds_read_b128 v[24:27], v74 offset:8192
    ds_read_b128 v[28:31], v74 offset:12288
    s_waitcnt lgkmcnt(9)
    v_mfma_f32_32x32x16_bf16 v[192:207], v[40:43], v[56:59], v[192:207]
    v_mfma_f32_32x32x16_bf16 v[208:223], v[40:43], v[60:63], v[208:223]
    s_waitcnt lgkmcnt(8)
    v_mfma_f32_32x32x16_bf16 v[224:239], v[44:47], v[56:59], v[224:239]
    v_mfma_f32_32x32x16_bf16 v[240:255], v[44:47], v[60:63], v[240:255]
    s_waitcnt lgkmcnt(5)
    v_mfma_f32_32x32x16_bf16 v[128:143], v[16:19], v[48:51], v[128:143]
    ds_read_b128 v[32:35], v75 offset:0
    ds_read_b64_tr_b16 v[56:57], v76 offset:45056
    s_waitcnt lgkmcnt(5)
    v_mfma_f32_32x32x16_bf16 v[144:159], v[16:19], v[52:55], v[144:159]
    ds_read_b64_tr_b16 v[58:59], v76 offset:46080
    ds_read_b64_tr_b16 v[60:61], v78 offset:45056
    s_waitcnt lgkmcnt(6)
    v_mfma_f32_32x32x16_bf16 v[160:175], v[20:23], v[48:51], v[160:175]
    ds_read_b64_tr_b16 v[62:63], v78 offset:46080
    ds_read_b128 v[36:39], v75 offset:4096
    v_mfma_f32_32x32x16_bf16 v[176:191], v[20:23], v[52:55], v[176:191]
    ds_read_b128 v[40:43], v75 offset:8192
    ds_read_b128 v[44:47], v75 offset:12288
    s_waitcnt lgkmcnt(9)
    v_mfma_f32_32x32x16_bf16 v[192:207], v[24:27], v[48:51], v[192:207]
    v_mfma_f32_32x32x16_bf16 v[208:223], v[24:27], v[52:55], v[208:223]
    s_waitcnt lgkmcnt(8)
    v_mfma_f32_32x32x16_bf16 v[224:239], v[28:31], v[48:51], v[224:239]
    v_mfma_f32_32x32x16_bf16 v[240:255], v[28:31], v[52:55], v[240:255]
    s_waitcnt lgkmcnt(5)
    v_mfma_f32_32x32x16_bf16 v[128:143], v[32:35], v[56:59], v[128:143]
    s_waitcnt vmcnt(8) lgkmcnt(0)
    s_barrier
    v_mfma_f32_32x32x16_bf16 v[144:159], v[32:35], v[60:63], v[144:159]
    ds_read_b128 v[16:19], v64 offset:36864
    ds_read_b64_tr_b16 v[48:49], v77 offset:0
    v_mfma_f32_32x32x16_bf16 v[160:175], v[36:39], v[56:59], v[160:175]
    ds_read_b64_tr_b16 v[50:51], v77 offset:1024
    ds_read_b64_tr_b16 v[52:53], v79 offset:0
    v_mfma_f32_32x32x16_bf16 v[176:191], v[36:39], v[60:63], v[176:191]
    ds_read_b64_tr_b16 v[54:55], v79 offset:1024
    ds_read_b128 v[20:23], v64 offset:40960
    v_mfma_f32_32x32x16_bf16 v[192:207], v[40:43], v[56:59], v[192:207]
    ds_read_b128 v[24:27], v64 offset:45056
    ds_read_b128 v[28:31], v64 offset:49152
    v_mfma_f32_32x32x16_bf16 v[208:223], v[40:43], v[60:63], v[208:223]
    s_add_u32 m0, s80, 32768
    s_add_u32 s50, s46, 2097152
    buffer_load_dwordx4 v80, s[12:15], s50 offen lds
    v_mfma_f32_32x32x16_bf16 v[224:239], v[44:47], v[56:59], v[224:239]
    s_add_u32 m0, s80, 33792
    s_add_u32 s50, s46, 2101248
    buffer_load_dwordx4 v80, s[12:15], s50 offen lds
    v_mfma_f32_32x32x16_bf16 v[240:255], v[44:47], v[60:63], v[240:255]
    s_add_u32 m0, s80, 34816
    s_add_u32 s50, s46, 2105344
    buffer_load_dwordx4 v80, s[12:15], s50 offen lds
    s_waitcnt lgkmcnt(5)
    v_mfma_f32_32x32x16_bf16 v[128:143], v[16:19], v[48:51], v[128:143]
    ds_read_b128 v[32:35], v65 offset:36864
    ds_read_b64_tr_b16 v[56:57], v77 offset:4096
    s_waitcnt lgkmcnt(5)
    v_mfma_f32_32x32x16_bf16 v[144:159], v[16:19], v[52:55], v[144:159]
    ds_read_b64_tr_b16 v[58:59], v77 offset:5120
    ds_read_b64_tr_b16 v[60:61], v79 offset:4096
    s_waitcnt lgkmcnt(6)
    v_mfma_f32_32x32x16_bf16 v[160:175], v[20:23], v[48:51], v[160:175]
    ds_read_b64_tr_b16 v[62:63], v79 offset:5120
    ds_read_b128 v[36:39], v65 offset:40960
    v_mfma_f32_32x32x16_bf16 v[176:191], v[20:23], v[52:55], v[176:191]
    ds_read_b128 v[40:43], v65 offset:45056
    ds_read_b128 v[44:47], v65 offset:49152
    s_waitcnt lgkmcnt(9)
    v_mfma_f32_32x32x16_bf16 v[192:207], v[24:27], v[48:51], v[192:207]
    s_add_u32 m0, s80, 35840
    s_add_u32 s50, s46, 2109440
    buffer_load_dwordx4 v80, s[12:15], s50 offen lds
    v_mfma_f32_32x32x16_bf16 v[208:223], v[24:27], v[52:55], v[208:223]
    s_add_u32 m0, s81, 81920
    s_add_u32 s51, s47, 0
    buffer_load_dwordx4 v81, s[8:11], s51 offen lds
    s_waitcnt lgkmcnt(8)
    v_mfma_f32_32x32x16_bf16 v[224:239], v[28:31], v[48:51], v[224:239]
    s_add_u32 m0, s81, 86016
    s_add_u32 s51, s47, 65536
    buffer_load_dwordx4 v81, s[8:11], s51 offen lds
    v_mfma_f32_32x32x16_bf16 v[240:255], v[28:31], v[52:55], v[240:255]
    s_add_u32 m0, s81, 90112
    s_add_u32 s51, s47, 131072
    buffer_load_dwordx4 v81, s[8:11], s51 offen lds
    s_waitcnt lgkmcnt(5)
    v_mfma_f32_32x32x16_bf16 v[128:143], v[32:35], v[56:59], v[128:143]
    ds_read_b128 v[16:19], v66 offset:36864
    ds_read_b64_tr_b16 v[48:49], v77 offset:8192
    s_waitcnt lgkmcnt(5)
    v_mfma_f32_32x32x16_bf16 v[144:159], v[32:35], v[60:63], v[144:159]
    ds_read_b64_tr_b16 v[50:51], v77 offset:9216
    ds_read_b64_tr_b16 v[52:53], v79 offset:8192
    s_waitcnt lgkmcnt(6)
    v_mfma_f32_32x32x16_bf16 v[160:175], v[36:39], v[56:59], v[160:175]
    ds_read_b64_tr_b16 v[54:55], v79 offset:9216
    ds_read_b128 v[20:23], v66 offset:40960
    v_mfma_f32_32x32x16_bf16 v[176:191], v[36:39], v[60:63], v[176:191]
    ds_read_b128 v[24:27], v66 offset:45056
    ds_read_b128 v[28:31], v66 offset:49152
    s_waitcnt lgkmcnt(9)
    v_mfma_f32_32x32x16_bf16 v[192:207], v[40:43], v[56:59], v[192:207]
    s_add_u32 m0, s81, 94208
    s_add_u32 s51, s47, 196608
    buffer_load_dwordx4 v81, s[8:11], s51 offen lds
    v_mfma_f32_32x32x16_bf16 v[208:223], v[40:43], v[60:63], v[208:223]
    s_add_u32 m0, s81, 98304
    s_add_u32 s51, s47, 262144
    buffer_load_dwordx4 v81, s[8:11], s51 offen lds
    s_waitcnt lgkmcnt(8)
    v_mfma_f32_32x32x16_bf16 v[224:239], v[44:47], v[56:59], v[224:239]
    s_add_u32 m0, s81, 102400
    s_add_u32 s51, s47, 327680
    buffer_load_dwordx4 v81, s[8:11], s51 offen lds
    v_mfma_f32_32x32x16_bf16 v[240:255], v[44:47], v[60:63], v[240:255]
    s_add_u32 m0, s81, 106496
    s_add_u32 s51, s47, 393216
    buffer_load_dwordx4 v81, s[8:11], s51 offen lds
    s_waitcnt lgkmcnt(5)
    v_mfma_f32_32x32x16_bf16 v[128:143], v[16:19], v[48:51], v[128:143]
    ds_read_b128 v[32:35], v67 offset:36864
    ds_read_b64_tr_b16 v[56:57], v77 offset:12288
    s_waitcnt lgkmcnt(5)
    v_mfma_f32_32x32x16_bf16 v[144:159], v[16:19], v[52:55], v[144:159]
    ds_read_b64_tr_b16 v[58:59], v77 offset:13312
    ds_read_b64_tr_b16 v[60:61], v79 offset:12288
    s_waitcnt lgkmcnt(6)
    v_mfma_f32_32x32x16_bf16 v[160:175], v[20:23], v[48:51], v[160:175]
    ds_read_b64_tr_b16 v[62:63], v79 offset:13312
    ds_read_b128 v[36:39], v67 offset:40960
    v_mfma_f32_32x32x16_bf16 v[176:191], v[20:23], v[52:55], v[176:191]
    ds_read_b128 v[40:43], v67 offset:45056
    ds_read_b128 v[44:47], v67 offset:49152
    s_waitcnt lgkmcnt(9)
    v_mfma_f32_32x32x16_bf16 v[192:207], v[24:27], v[48:51], v[192:207]
    s_add_u32 m0, s81, 110592
    s_add_u32 s51, s47, 458752
    buffer_load_dwordx4 v81, s[8:11], s51 offen lds
    v_mfma_f32_32x32x16_bf16 v[208:223], v[24:27], v[52:55], v[208:223]
    s_add_u32 m0, s81, 114688
    s_add_u32 s51, s49, 524288
    buffer_load_dwordx4 v81, s[8:11], s51 offen lds
    s_waitcnt lgkmcnt(8)
    v_mfma_f32_32x32x16_bf16 v[224:239], v[28:31], v[48:51], v[224:239]
    v_mfma_f32_32x32x16_bf16 v[240:255], v[28:31], v[52:55], v[240:255]
    s_waitcnt lgkmcnt(5)
    v_mfma_f32_32x32x16_bf16 v[128:143], v[32:35], v[56:59], v[128:143]
    s_waitcnt vmcnt(30) lgkmcnt(0)
    s_barrier
    v_mfma_f32_32x32x16_bf16 v[144:159], v[32:35], v[60:63], v[144:159]
    ds_read_b128 v[16:19], v68 offset:36864
    ds_read_b64_tr_b16 v[48:49], v77 offset:16384
    v_mfma_f32_32x32x16_bf16 v[160:175], v[36:39], v[56:59], v[160:175]
    ds_read_b64_tr_b16 v[50:51], v77 offset:17408
    ds_read_b64_tr_b16 v[52:53], v79 offset:16384
    v_mfma_f32_32x32x16_bf16 v[176:191], v[36:39], v[60:63], v[176:191]
    ds_read_b64_tr_b16 v[54:55], v79 offset:17408
    ds_read_b128 v[20:23], v68 offset:40960
    v_mfma_f32_32x32x16_bf16 v[192:207], v[40:43], v[56:59], v[192:207]
    ds_read_b128 v[24:27], v68 offset:45056
    ds_read_b128 v[28:31], v68 offset:49152
    v_mfma_f32_32x32x16_bf16 v[208:223], v[40:43], v[60:63], v[208:223]
    s_add_u32 m0, s80, 49152
    s_add_u32 s50, s46, 524288
    buffer_load_dwordx4 v80, s[12:15], s50 offen lds
    v_mfma_f32_32x32x16_bf16 v[224:239], v[44:47], v[56:59], v[224:239]
    s_add_u32 m0, s80, 50176
    s_add_u32 s50, s46, 528384
    buffer_load_dwordx4 v80, s[12:15], s50 offen lds
    v_mfma_f32_32x32x16_bf16 v[240:255], v[44:47], v[60:63], v[240:255]
    s_add_u32 m0, s80, 51200
    s_add_u32 s50, s46, 532480
    buffer_load_dwordx4 v80, s[12:15], s50 offen lds
    s_waitcnt lgkmcnt(5)
    v_mfma_f32_32x32x16_bf16 v[128:143], v[16:19], v[48:51], v[128:143]
    ds_read_b128 v[32:35], v69 offset:36864
    ds_read_b64_tr_b16 v[56:57], v77 offset:20480
    s_waitcnt lgkmcnt(5)
    v_mfma_f32_32x32x16_bf16 v[144:159], v[16:19], v[52:55], v[144:159]
    ds_read_b64_tr_b16 v[58:59], v77 offset:21504
    ds_read_b64_tr_b16 v[60:61], v79 offset:20480
    s_waitcnt lgkmcnt(6)
    v_mfma_f32_32x32x16_bf16 v[160:175], v[20:23], v[48:51], v[160:175]
    ds_read_b64_tr_b16 v[62:63], v79 offset:21504
    ds_read_b128 v[36:39], v69 offset:40960
    v_mfma_f32_32x32x16_bf16 v[176:191], v[20:23], v[52:55], v[176:191]
    ds_read_b128 v[40:43], v69 offset:45056
    ds_read_b128 v[44:47], v69 offset:49152
    s_waitcnt lgkmcnt(9)
    v_mfma_f32_32x32x16_bf16 v[192:207], v[24:27], v[48:51], v[192:207]
    s_add_u32 m0, s80, 52224
    s_add_u32 s50, s46, 536576
    buffer_load_dwordx4 v80, s[12:15], s50 offen lds
    v_mfma_f32_32x32x16_bf16 v[208:223], v[24:27], v[52:55], v[208:223]
    s_waitcnt lgkmcnt(8)
    v_mfma_f32_32x32x16_bf16 v[224:239], v[28:31], v[48:51], v[224:239]
    v_mfma_f32_32x32x16_bf16 v[240:255], v[28:31], v[52:55], v[240:255]
    s_waitcnt lgkmcnt(5)
    v_mfma_f32_32x32x16_bf16 v[128:143], v[32:35], v[56:59], v[128:143]
    ds_read_b128 v[16:19], v70 offset:36864
    ds_read_b64_tr_b16 v[48:49], v77 offset:24576
    s_waitcnt lgkmcnt(5)
    v_mfma_f32_32x32x16_bf16 v[144:159], v[32:35], v[60:63], v[144:159]
    ds_read_b64_tr_b16 v[50:51], v77 offset:25600
    ds_read_b64_tr_b16 v[52:53], v79 offset:24576
    s_waitcnt lgkmcnt(6)
    v_mfma_f32_32x32x16_bf16 v[160:175], v[36:39], v[56:59], v[160:175]
    ds_read_b64_tr_b16 v[54:55], v79 offset:25600
    ds_read_b128 v[20:23], v70 offset:40960
    v_mfma_f32_32x32x16_bf16 v[176:191], v[36:39], v[60:63], v[176:191]
    ds_read_b128 v[24:27], v70 offset:45056
    ds_read_b128 v[28:31], v70 offset:49152
    s_waitcnt lgkmcnt(9)
    v_mfma_f32_32x32x16_bf16 v[192:207], v[40:43], v[56:59], v[192:207]
    v_mfma_f32_32x32x16_bf16 v[208:223], v[40:43], v[60:63], v[208:223]
    s_waitcnt lgkmcnt(8)
    v_mfma_f32_32x32x16_bf16 v[224:239], v[44:47], v[56:59], v[224:239]
    v_mfma_f32_32x32x16_bf16 v[240:255], v[44:47], v[60:63], v[240:255]
    s_waitcnt lgkmcnt(5)
    v_mfma_f32_32x32x16_bf16 v[128:143], v[16:19], v[48:51], v[128:143]
    ds_read_b128 v[32:35], v71 offset:36864
    ds_read_b64_tr_b16 v[56:57], v77 offset:28672
    s_waitcnt lgkmcnt(5)
    v_mfma_f32_32x32x16_bf16 v[144:159], v[16:19], v[52:55], v[144:159]
    ds_read_b64_tr_b16 v[58:59], v77 offset:29696
    ds_read_b64_tr_b16 v[60:61], v79 offset:28672
    s_waitcnt lgkmcnt(6)
    v_mfma_f32_32x32x16_bf16 v[160:175], v[20:23], v[48:51], v[160:175]
    ds_read_b64_tr_b16 v[62:63], v79 offset:29696
    ds_read_b128 v[36:39], v71 offset:40960
    v_mfma_f32_32x32x16_bf16 v[176:191], v[20:23], v[52:55], v[176:191]
    ds_read_b128 v[40:43], v71 offset:45056
    ds_read_b128 v[44:47], v71 offset:49152
    s_waitcnt lgkmcnt(9)
    v_mfma_f32_32x32x16_bf16 v[192:207], v[24:27], v[48:51], v[192:207]
    v_mfma_f32_32x32x16_bf16 v[208:223], v[24:27], v[52:55], v[208:223]
    s_waitcnt lgkmcnt(8)
    v_mfma_f32_32x32x16_bf16 v[224:239], v[28:31], v[48:51], v[224:239]
    v_mfma_f32_32x32x16_bf16 v[240:255], v[28:31], v[52:55], v[240:255]
    s_waitcnt lgkmcnt(5)
    v_mfma_f32_32x32x16_bf16 v[128:143], v[32:35], v[56:59], v[128:143]
    s_waitcnt vmcnt(4) lgkmcnt(0)
    s_barrier
    v_mfma_f32_32x32x16_bf16 v[144:159], v[32:35], v[60:63], v[144:159]
    ds_read_b128 v[16:19], v64 offset:0
    ds_read_b64_tr_b16 v[48:49], v76 offset:0
    v_mfma_f32_32x32x16_bf16 v[160:175], v[36:39], v[56:59], v[160:175]
    ds_read_b64_tr_b16 v[50:51], v76 offset:1024
    ds_read_b64_tr_b16 v[52:53], v78 offset:0
    v_mfma_f32_32x32x16_bf16 v[176:191], v[36:39], v[60:63], v[176:191]
    ds_read_b64_tr_b16 v[54:55], v78 offset:1024
    ds_read_b128 v[20:23], v64 offset:4096
    v_mfma_f32_32x32x16_bf16 v[192:207], v[40:43], v[56:59], v[192:207]
    ds_read_b128 v[24:27], v64 offset:8192
    ds_read_b128 v[28:31], v64 offset:12288
    v_mfma_f32_32x32x16_bf16 v[208:223], v[40:43], v[60:63], v[208:223]
    s_add_u32 m0, s80, 65536
    s_add_u32 s50, s46, 1572864
    buffer_load_dwordx4 v80, s[12:15], s50 offen lds
    v_mfma_f32_32x32x16_bf16 v[224:239], v[44:47], v[56:59], v[224:239]
    s_add_u32 m0, s80, 66560
    s_add_u32 s50, s46, 1576960
    buffer_load_dwordx4 v80, s[12:15], s50 offen lds
    v_mfma_f32_32x32x16_bf16 v[240:255], v[44:47], v[60:63], v[240:255]
    s_add_u32 m0, s80, 67584
    s_add_u32 s50, s46, 1581056
    buffer_load_dwordx4 v80, s[12:15], s50 offen lds
    s_add_u32 m0, s80, 68608
    s_add_u32 s50, s46, 1585152
    buffer_load_dwordx4 v80, s[12:15], s50 offen lds
    s_add_u32 s45, s45, 1
    s_add_u32 s46, s46, 65536
    s_add_u32 s47, s47, 128
    s_add_u32 s49, s49, 128
    s_cmp_lt_u32 s45, 7
    s_cbranch_scc1 L_loop
    s_waitcnt lgkmcnt(5)
    v_mfma_f32_32x32x16_bf16 v[128:143], v[16:19], v[48:51], v[128:143]
    ds_read_b128 v[32:35], v65 offset:0
    ds_read_b64_tr_b16 v[56:57], v76 offset:4096
    s_waitcnt lgkmcnt(5)
    v_mfma_f32_32x32x16_bf16 v[144:159], v[16:19], v[52:55], v[144:159]
    ds_read_b64_tr_b16 v[58:59], v76 offset:5120
    ds_read_b64_tr_b16 v[60:61], v78 offset:4096
    s_waitcnt lgkmcnt(6)
    v_mfma_f32_32x32x16_bf16 v[160:175], v[20:23], v[48:51], v[160:175]
    ds_read_b64_tr_b16 v[62:63], v78 offset:5120
    ds_read_b128 v[36:39], v65 offset:4096
    v_mfma_f32_32x32x16_bf16 v[176:191], v[20:23], v[52:55], v[176:191]
    ds_read_b128 v[40:43], v65 offset:8192
    ds_read_b128 v[44:47], v65 offset:12288
    s_waitcnt lgkmcnt(9)
    v_mfma_f32_32x32x16_bf16 v[192:207], v[24:27], v[48:51], v[192:207]
    s_add_u32 m0, s81, 118784
    s_add_u32 s51, s47, 896
    buffer_load_dwordx4 v81, s[8:11], s51 offen lds
    v_mfma_f32_32x32x16_bf16 v[208:223], v[24:27], v[52:55], v[208:223]
    s_add_u32 m0, s81, 122880
    s_add_u32 s51, s47, 66432
    buffer_load_dwordx4 v81, s[8:11], s51 offen lds
    s_waitcnt lgkmcnt(8)
    v_mfma_f32_32x32x16_bf16 v[224:239], v[28:31], v[48:51], v[224:239]
    s_add_u32 m0, s81, 126976
    s_add_u32 s51, s47, 131968
    buffer_load_dwordx4 v81, s[8:11], s51 offen lds
    v_mfma_f32_32x32x16_bf16 v[240:255], v[28:31], v[52:55], v[240:255]
    s_add_u32 m0, s81, 131072
    s_add_u32 s51, s47, 197504
    buffer_load_dwordx4 v81, s[8:11], s51 offen lds
    s_waitcnt lgkmcnt(5)
    v_mfma_f32_32x32x16_bf16 v[128:143], v[32:35], v[56:59], v[128:143]
    ds_read_b128 v[16:19], v66 offset:0
    ds_read_b64_tr_b16 v[48:49], v76 offset:8192
    s_waitcnt lgkmcnt(5)
    v_mfma_f32_32x32x16_bf16 v[144:159], v[32:35], v[60:63], v[144:159]
    ds_read_b64_tr_b16 v[50:51], v76 offset:9216
    ds_read_b64_tr_b16 v[52:53], v78 offset:8192
    s_waitcnt lgkmcnt(6)
    v_mfma_f32_32x32x16_bf16 v[160:175], v[36:39], v[56:59], v[160:175]
    ds_read_b64_tr_b16 v[54:55], v78 offset:9216
    ds_read_b128 v[20:23], v66 offset:4096
    v_mfma_f32_32x32x16_bf16 v[176:191], v[36:39], v[60:63], v[176:191]
    ds_read_b128 v[24:27], v66 offset:8192
    ds_read_b128 v[28:31], v66 offset:12288
    s_waitcnt lgkmcnt(9)
    v_mfma_f32_32x32x16_bf16 v[192:207], v[40:43], v[56:59], v[192:207]
    s_add_u32 m0, s81, 135168
    s_add_u32 s51, s47, 263040
    buffer_load_dwordx4 v81, s[8:11], s51 offen lds
    v_mfma_f32_32x32x16_bf16 v[208:223], v[40:43], v[60:63], v[208:223]
    s_add_u32 m0, s81, 139264
    s_add_u32 s51, s47, 328576
    buffer_load_dwordx4 v81, s[8:11], s51 offen lds
    s_waitcnt lgkmcnt(8)
    v_mfma_f32_32x32x16_bf16 v[224:239], v[44:47], v[56:59], v[224:239]
    s_add_u32 m0, s81, 143360
    s_add_u32 s51, s47, 394112
    buffer_load_dwordx4 v81, s[8:11], s51 offen lds
    v_mfma_f32_32x32x16_bf16 v[240:255], v[44:47], v[60:63], v[240:255]
    s_add_u32 m0, s81, 147456
    s_add_u32 s51, s47, 459648
    buffer_load_dwordx4 v81, s[8:11], s51 offen lds
    s_waitcnt lgkmcnt(5)
    v_mfma_f32_32x32x16_bf16 v[128:143], v[16:19], v[48:51], v[128:143]
    ds_read_b128 v[32:35], v67 offset:0
    ds_read_b64_tr_b16 v[56:57], v76 offset:12288
    s_waitcnt lgkmcnt(5)
    v_mfma_f32_32x32x16_bf16 v[144:159], v[16:19], v[52:55], v[144:159]
    ds_read_b64_tr_b16 v[58:59], v76 offset:13312
    ds_read_b64_tr_b16 v[60:61], v78 offset:12288
    s_waitcnt lgkmcnt(6)
    v_mfma_f32_32x32x16_bf16 v[160:175], v[20:23], v[48:51], v[160:175]
    ds_read_b64_tr_b16 v[62:63], v78 offset:13312
    ds_read_b128 v[36:39], v67 offset:4096
    v_mfma_f32_32x32x16_bf16 v[176:191], v[20:23], v[52:55], v[176:191]
    ds_read_b128 v[40:43], v67 offset:8192
    ds_read_b128 v[44:47], v67 offset:12288
    s_waitcnt lgkmcnt(9)
    v_mfma_f32_32x32x16_bf16 v[192:207], v[24:27], v[48:51], v[192:207]
    s_add_u32 m0, s81, 151552
    s_add_u32 s51, s49, 525184
    buffer_load_dwordx4 v81, s[8:11], s51 offen lds
    v_mfma_f32_32x32x16_bf16 v[208:223], v[24:27], v[52:55], v[208:223]
    s_waitcnt lgkmcnt(8)
    v_mfma_f32_32x32x16_bf16 v[224:239], v[28:31], v[48:51], v[224:239]
    v_mfma_f32_32x32x16_bf16 v[240:255], v[28:31], v[52:55], v[240:255]
    s_waitcnt lgkmcnt(5)
    v_mfma_f32_32x32x16_bf16 v[128:143], v[32:35], v[56:59], v[128:143]
    s_waitcnt vmcnt(30) lgkmcnt(0)
    s_barrier
    v_mfma_f32_32x32x16_bf16 v[144:159], v[32:35], v[60:63], v[144:159]
    ds_read_b128 v[16:19], v68 offset:0
    ds_read_b64_tr_b16 v[48:49], v76 offset:16384
    v_mfma_f32_32x32x16_bf16 v[160:175], v[36:39], v[56:59], v[160:175]
    ds_read_b64_tr_b16 v[50:51], v76 offset:17408
    ds_read_b64_tr_b16 v[52:53], v78 offset:16384
    v_mfma_f32_32x32x16_bf16 v[176:191], v[36:39], v[60:63], v[176:191]
    ds_read_b64_tr_b16 v[54:55], v78 offset:17408
    ds_read_b128 v[20:23], v68 offset:4096
    v_mfma_f32_32x32x16_bf16 v[192:207], v[40:43], v[56:59], v[192:207]
    ds_read_b128 v[24:27], v68 offset:8192
    ds_read_b128 v[28:31], v68 offset:12288
    v_mfma_f32_32x32x16_bf16 v[208:223], v[40:43], v[60:63], v[208:223]
    v_mfma_f32_32x32x16_bf16 v[224:239], v[44:47], v[56:59], v[224:239]
    v_mfma_f32_32x32x16_bf16 v[240:255], v[44:47], v[60:63], v[240:255]
    s_waitcnt lgkmcnt(5)
    v_mfma_f32_32x32x16_bf16 v[128:143], v[16:19], v[48:51], v[128:143]
    ds_read_b128 v[32:35], v69 offset:0
    ds_read_b64_tr_b16 v[56:57], v76 offset:20480
    s_waitcnt lgkmcnt(5)
    v_mfma_f32_32x32x16_bf16 v[144:159], v[16:19], v[52:55], v[144:159]
    ds_read_b64_tr_b16 v[58:59], v76 offset:21504
    ds_read_b64_tr_b16 v[60:61], v78 offset:20480
    s_waitcnt lgkmcnt(6)
    v_mfma_f32_32x32x16_bf16 v[160:175], v[20:23], v[48:51], v[160:175]
    ds_read_b64_tr_b16 v[62:63], v78 offset:21504
    ds_read_b128 v[36:39], v69 offset:4096
    v_mfma_f32_32x32x16_bf16 v[176:191], v[20:23], v[52:55], v[176:191]
    ds_read_b128 v[40:43], v69 offset:8192
    ds_read_b128 v[44:47], v69 offset:12288
    s_waitcnt lgkmcnt(9)
    v_mfma_f32_32x32x16_bf16 v[192:207], v[24:27], v[48:51], v[192:207]
    v_mfma_f32_32x32x16_bf16 v[208:223], v[24:27], v[52:55], v[208:223]
    s_waitcnt lgkmcnt(8)
    v_mfma_f32_32x32x16_bf16 v[224:239], v[28:31], v[48:51], v[224:239]
    v_mfma_f32_32x32x16_bf16 v[240:255], v[28:31], v[52:55], v[240:255]
    s_waitcnt lgkmcnt(5)
    v_mfma_f32_32x32x16_bf16 v[128:143], v[32:35], v[56:59], v[128:143]
    ds_read_b128 v[16:19], v70 offset:0
    ds_read_b64_tr_b16 v[48:49], v76 offset:24576
    s_waitcnt lgkmcnt(5)
    v_mfma_f32_32x32x16_bf16 v[144:159], v[32:35], v[60:63], v[144:159]
    ds_read_b64_tr_b16 v[50:51], v76 offset:25600
    ds_read_b64_tr_b16 v[52:53], v78 offset:24576
    s_waitcnt lgkmcnt(6)
    v_mfma_f32_32x32x16_bf16 v[160:175], v[36:39], v[56:59], v[160:175]
    ds_read_b64_tr_b16 v[54:55], v78 offset:25600
    ds_read_b128 v[20:23], v70 offset:4096
    v_mfma_f32_32x32x16_bf16 v[176:191], v[36:39], v[60:63], v[176:191]
    ds_read_b128 v[24:27], v70 offset:8192
    ds_read_b128 v[28:31], v70 offset:12288
    s_waitcnt lgkmcnt(9)
    v_mfma_f32_32x32x16_bf16 v[192:207], v[40:43], v[56:59], v[192:207]
    v_mfma_f32_32x32x16_bf16 v[208:223], v[40:43], v[60:63], v[208:223]
    s_waitcnt lgkmcnt(8)
    v_mfma_f32_32x32x16_bf16 v[224:239], v[44:47], v[56:59], v[224:239]
    v_mfma_f32_32x32x16_bf16 v[240:255], v[44:47], v[60:63], v[240:255]
    s_waitcnt lgkmcnt(5)
    v_mfma_f32_32x32x16_bf16 v[128:143], v[16:19], v[48:51], v[128:143]
    ds_read_b128 v[32:35], v71 offset:0
    ds_read_b64_tr_b16 v[56:57], v76 offset:28672
    s_waitcnt lgkmcnt(5)
    v_mfma_f32_32x32x16_bf16 v[144:159], v[16:19], v[52:55], v[144:159]
    ds_read_b64_tr_b16 v[58:59], v76 offset:29696
    ds_read_b64_tr_b16 v[60:61], v78 offset:28672
    s_waitcnt lgkmcnt(6)
    v_mfma_f32_32x32x16_bf16 v[160:175], v[20:23], v[48:51], v[160:175]
    ds_read_b64_tr_b16 v[62:63], v78 offset:29696
    ds_read_b128 v[36:39], v71 offset:4096
    v_mfma_f32_32x32x16_bf16 v[176:191], v[20:23], v[52:55], v[176:191]
    ds_read_b128 v[40:43], v71 offset:8192
    ds_read_b128 v[44:47], v71 offset:12288
    s_waitcnt lgkmcnt(9)
    v_mfma_f32_32x32x16_bf16 v[192:207], v[24:27], v[48:51], v[192:207]
    v_mfma_f32_32x32x16_bf16 v[208:223], v[24:27], v[52:55], v[208:223]
    s_waitcnt lgkmcnt(8)
    v_mfma_f32_32x32x16_bf16 v[224:239], v[28:31], v[48:51], v[224:239]
    v_mfma_f32_32x32x16_bf16 v[240:255], v[28:31], v[52:55], v[240:255]
    s_waitcnt lgkmcnt(5)
    v_mfma_f32_32x32x16_bf16 v[128:143], v[32:35], v[56:59], v[128:143]
    s_waitcnt vmcnt(26) lgkmcnt(0)
    s_barrier
    v_mfma_f32_32x32x16_bf16 v[144:159], v[32:35], v[60:63], v[144:159]
    ds_read_b128 v[16:19], v72 offset:0
    ds_read_b64_tr_b16 v[48:49], v76 offset:32768
    v_mfma_f32_32x32x16_bf16 v[160:175], v[36:39], v[56:59], v[160:175]
    ds_read_b64_tr_b16 v[50:51], v76 offset:33792
    ds_read_b64_tr_b16 v[52:53], v78 offset:32768
    v_mfma_f32_32x32x16_bf16 v[176:191], v[36:39], v[60:63], v[176:191]
    ds_read_b64_tr_b16 v[54:55], v78 offset:33792
    ds_read_b128 v[20:23], v72 offset:4096
    v_mfma_f32_32x32x16_bf16 v[192:207], v[40:43], v[56:59], v[192:207]
    ds_read_b128 v[24:27], v72 offset:8192
    ds_read_b128 v[28:31], v72 offset:12288
    v_mfma_f32_32x32x16_bf16 v[208:223], v[40:43], v[60:63], v[208:223]
    v_mfma_f32_32x32x16_bf16 v[224:239], v[44:47], v[56:59], v[224:239]
    v_mfma_f32_32x32x16_bf16 v[240:255], v[44:47], v[60:63], v[240:255]
    s_waitcnt lgkmcnt(5)
    v_mfma_f32_32x32x16_bf16 v[128:143], v[16:19], v[48:51], v[128:143]
    ds_read_b128 v[32:35], v73 offset:0
    ds_read_b64_tr_b16 v[56:57], v76 offset:36864
    s_waitcnt lgkmcnt(5)
    v_mfma_f32_32x32x16_bf16 v[144:159], v[16:19], v[52:55], v[144:159]
    ds_read_b64_tr_b16 v[58:59], v76 offset:37888
    ds_read_b64_tr_b16 v[60:61], v78 offset:36864
    s_waitcnt lgkmcnt(6)
    v_mfma_f32_32x32x16_bf16 v[160:175], v[20:23], v[48:51], v[160:175]
    ds_read_b64_tr_b16 v[62:63], v78 offset:37888
    ds_read_b128 v[36:39], v73 offset:4096
    v_mfma_f32_32x32x16_bf16 v[176:191], v[20:23], v[52:55], v[176:191]
    ds_read_b128 v[40:43], v73 offset:8192
    ds_read_b128 v[44:47], v73 offset:12288
    s_waitcnt lgkmcnt(9)
    v_mfma_f32_32x32x16_bf16 v[192:207], v[24:27], v[48:51], v[192:207]
    v_mfma_f32_32x32x16_bf16 v[208:223], v[24:27], v[52:55], v[208:223]
    s_waitcnt lgkmcnt(8)
    v_mfma_f32_32x32x16_bf16 v[224:239], v[28:31], v[48:51], v[224:239]
    v_mfma_f32_32x32x16_bf16 v[240:255], v[28:31], v[52:55], v[240:255]
    s_waitcnt lgkmcnt(5)
    v_mfma_f32_32x32x16_bf16 v[128:143], v[32:35], v[56:59], v[128:143]
    ds_read_b128 v[16:19], v74 offset:0
    ds_read_b64_tr_b16 v[48:49], v76 offset:40960
    s_waitcnt lgkmcnt(5)
    v_mfma_f32_32x32x16_bf16 v[144:159], v[32:35], v[60:63], v[144:159]
    ds_read_b64_tr_b16 v[50:51], v76 offset:41984
    ds_read_b64_tr_b16 v[52:53], v78 offset:40960
    s_waitcnt lgkmcnt(6)
    v_mfma_f32_32x32x16_bf16 v[160:175], v[36:39], v[56:59], v[160:175]
    ds_read_b64_tr_b16 v[54:55], v78 offset:41984
    ds_read_b128 v[20:23], v74 offset:4096
    v_mfma_f32_32x32x16_bf16 v[176:191], v[36:39], v[60:63], v[176:191]
    ds_read_b128 v[24:27], v74 offset:8192
    ds_read_b128 v[28:31], v74 offset:12288
    s_waitcnt lgkmcnt(9)
    v_mfma_f32_32x32x16_bf16 v[192:207], v[40:43], v[56:59], v[192:207]
    v_mfma_f32_32x32x16_bf16 v[208:223], v[40:43], v[60:63], v[208:223]
    s_waitcnt lgkmcnt(8)
    v_mfma_f32_32x32x16_bf16 v[224:239], v[44:47], v[56:59], v[224:239]
    v_mfma_f32_32x32x16_bf16 v[240:255], v[44:47], v[60:63], v[240:255]
    s_waitcnt lgkmcnt(5)
    v_mfma_f32_32x32x16_bf16 v[128:143], v[16:19], v[48:51], v[128:143]
    ds_read_b128 v[32:35], v75 offset:0
    ds_read_b64_tr_b16 v[56:57], v76 offset:45056
    s_waitcnt lgkmcnt(5)
    v_mfma_f32_32x32x16_bf16 v[144:159], v[16:19], v[52:55], v[144:159]
    ds_read_b64_tr_b16 v[58:59], v76 offset:46080
    ds_read_b64_tr_b16 v[60:61], v78 offset:45056
    s_waitcnt lgkmcnt(6)
    v_mfma_f32_32x32x16_bf16 v[160:175], v[20:23], v[48:51], v[160:175]
    ds_read_b64_tr_b16 v[62:63], v78 offset:46080
    ds_read_b128 v[36:39], v75 offset:4096
    v_mfma_f32_32x32x16_bf16 v[176:191], v[20:23], v[52:55], v[176:191]
    ds_read_b128 v[40:43], v75 offset:8192
    ds_read_b128 v[44:47], v75 offset:12288
    s_waitcnt lgkmcnt(9)
    v_mfma_f32_32x32x16_bf16 v[192:207], v[24:27], v[48:51], v[192:207]
    v_mfma_f32_32x32x16_bf16 v[208:223], v[24:27], v[52:55], v[208:223]
    s_waitcnt lgkmcnt(8)
    v_mfma_f32_32x32x16_bf16 v[224:239], v[28:31], v[48:51], v[224:239]
    v_mfma_f32_32x32x16_bf16 v[240:255], v[28:31], v[52:55], v[240:255]
    s_waitcnt lgkmcnt(5)
    v_mfma_f32_32x32x16_bf16 v[128:143], v[32:35], v[56:59], v[128:143]
    s_waitcnt vmcnt(0) lgkmcnt(0)
    s_barrier
    v_mfma_f32_32x32x16_bf16 v[144:159], v[32:35], v[60:63], v[144:159]
    ds_read_b128 v[16:19], v64 offset:36864
    ds_read_b64_tr_b16 v[48:49], v77 offset:0
    v_mfma_f32_32x32x16_bf16 v[160:175], v[36:39], v[56:59], v[160:175]
    ds_read_b64_tr_b16 v[50:51], v77 offset:1024
    ds_read_b64_tr_b16 v[52:53], v79 offset:0
    v_mfma_f32_32x32x16_bf16 v[176:191], v[36:39], v[60:63], v[176:191]
    ds_read_b64_tr_b16 v[54:55], v79 offset:1024
    ds_read_b128 v[20:23], v64 offset:40960
    v_mfma_f32_32x32x16_bf16 v[192:207], v[40:43], v[56:59], v[192:207]
    ds_read_b128 v[24:27], v64 offset:45056
    ds_read_b128 v[28:31], v64 offset:49152
    v_mfma_f32_32x32x16_bf16 v[208:223], v[40:43], v[60:63], v[208:223]
    v_mfma_f32_32x32x16_bf16 v[224:239], v[44:47], v[56:59], v[224:239]
    v_mfma_f32_32x32x16_bf16 v[240:255], v[44:47], v[60:63], v[240:255]
    s_waitcnt lgkmcnt(5)
    v_mfma_f32_32x32x16_bf16 v[128:143], v[16:19], v[48:51], v[128:143]
    ds_read_b128 v[32:35], v65 offset:36864
    ds_read_b64_tr_b16 v[56:57], v77 offset:4096
    s_waitcnt lgkmcnt(5)
    v_mfma_f32_32x32x16_bf16 v[144:159], v[16:19], v[52:55], v[144:159]
    ds_read_b64_tr_b16 v[58:59], v77 offset:5120
    ds_read_b64_tr_b16 v[60:61], v79 offset:4096
    s_waitcnt lgkmcnt(6)
    v_mfma_f32_32x32x16_bf16 v[160:175], v[20:23], v[48:51], v[160:175]
    ds_read_b64_tr_b16 v[62:63], v79 offset:5120
    ds_read_b128 v[36:39], v65 offset:40960
    v_mfma_f32_32x32x16_bf16 v[176:191], v[20:23], v[52:55], v[176:191]
    ds_read_b128 v[40:43], v65 offset:45056
    ds_read_b128 v[44:47], v65 offset:49152
    s_waitcnt lgkmcnt(9)
    v_mfma_f32_32x32x16_bf16 v[192:207], v[24:27], v[48:51], v[192:207]
    v_mfma_f32_32x32x16_bf16 v[208:223], v[24:27], v[52:55], v[208:223]
    s_waitcnt lgkmcnt(8)
    v_mfma_f32_32x32x16_bf16 v[224:239], v[28:31], v[48:51], v[224:239]
    v_mfma_f32_32x32x16_bf16 v[240:255], v[28:31], v[52:55], v[240:255]
    s_waitcnt lgkmcnt(5)
    v_mfma_f32_32x32x16_bf16 v[128:143], v[32:35], v[56:59], v[128:143]
    ds_read_b128 v[16:19], v66 offset:36864
    ds_read_b64_tr_b16 v[48:49], v77 offset:8192
    s_waitcnt lgkmcnt(5)
    v_mfma_f32_32x32x16_bf16 v[144:159], v[32:35], v[60:63], v[144:159]
    ds_read_b64_tr_b16 v[50:51], v77 offset:9216
    ds_read_b64_tr_b16 v[52:53], v79 offset:8192
    s_waitcnt lgkmcnt(6)
    v_mfma_f32_32x32x16_bf16 v[160:175], v[36:39], v[56:59], v[160:175]
    ds_read_b64_tr_b16 v[54:55], v79 offset:9216
    ds_read_b128 v[20:23], v66 offset:40960
    v_mfma_f32_32x32x16_bf16 v[176:191], v[36:39], v[60:63], v[176:191]
    ds_read_b128 v[24:27], v66 offset:45056
    ds_read_b128 v[28:31], v66 offset:49152
    s_waitcnt lgkmcnt(9)
    v_mfma_f32_32x32x16_bf16 v[192:207], v[40:43], v[56:59], v[192:207]
    v_mfma_f32_32x32x16_bf16 v[208:223], v[40:43], v[60:63], v[208:223]
    s_waitcnt lgkmcnt(8)
    v_mfma_f32_32x32x16_bf16 v[224:239], v[44:47], v[56:59], v[224:239]
    v_mfma_f32_32x32x16_bf16 v[240:255], v[44:47], v[60:63], v[240:255]
    s_waitcnt lgkmcnt(5)
    v_mfma_f32_32x32x16_bf16 v[128:143], v[16:19], v[48:51], v[128:143]
    ds_read_b128 v[32:35], v67 offset:36864
    ds_read_b64_tr_b16 v[56:57], v77 offset:12288
    s_waitcnt lgkmcnt(5)
    v_mfma_f32_32x32x16_bf16 v[144:159], v[16:19], v[52:55], v[144:159]
    ds_read_b64_tr_b16 v[58:59], v77 offset:13312
    ds_read_b64_tr_b16 v[60:61], v79 offset:12288
    s_waitcnt lgkmcnt(6)
    v_mfma_f32_32x32x16_bf16 v[160:175], v[20:23], v[48:51], v[160:175]
    ds_read_b64_tr_b16 v[62:63], v79 offset:13312
    ds_read_b128 v[36:39], v67 offset:40960
    v_mfma_f32_32x32x16_bf16 v[176:191], v[20:23], v[52:55], v[176:191]
    ds_read_b128 v[40:43], v67 offset:45056
    ds_read_b128 v[44:47], v67 offset:49152
    s_waitcnt lgkmcnt(9)
    v_mfma_f32_32x32x16_bf16 v[192:207], v[24:27], v[48:51], v[192:207]
    v_mfma_f32_32x32x16_bf16 v[208:223], v[24:27], v[52:55], v[208:223]
    s_waitcnt lgkmcnt(8)
    v_mfma_f32_32x32x16_bf16 v[224:239], v[28:31], v[48:51], v[224:239]
    v_mfma_f32_32x32x16_bf16 v[240:255], v[28:31], v[52:55], v[240:255]
    s_waitcnt lgkmcnt(5)
    v_mfma_f32_32x32x16_bf16 v[128:143], v[32:35], v[56:59], v[128:143]
    s_waitcnt vmcnt(9) lgkmcnt(0)
    s_barrier
    v_mfma_f32_32x32x16_bf16 v[144:159], v[32:35], v[60:63], v[144:159]
    ds_read_b128 v[16:19], v68 offset:36864
    ds_read_b64_tr_b16 v[48:49], v77 offset:16384
    v_mfma_f32_32x32x16_bf16 v[160:175], v[36:39], v[56:59], v[160:175]
    ds_read_b64_tr_b16 v[50:51], v77 offset:17408
    ds_read_b64_tr_b16 v[52:53], v79 offset:16384
    v_mfma_f32_32x32x16_bf16 v[176:191], v[36:39], v[60:63], v[176:191]
    ds_read_b64_tr_b16 v[54:55], v79 offset:17408
    ds_read_b128 v[20:23], v68 offset:40960
    v_mfma_f32_32x32x16_bf16 v[192:207], v[40:43], v[56:59], v[192:207]
    ds_read_b128 v[24:27], v68 offset:45056
    ds_read_b128 v[28:31], v68 offset:49152
    v_mfma_f32_32x32x16_bf16 v[208:223], v[40:43], v[60:63], v[208:223]
    v_mfma_f32_32x32x16_bf16 v[224:239], v[44:47], v[56:59], v[224:239]
    v_mfma_f32_32x32x16_bf16 v[240:255], v[44:47], v[60:63], v[240:255]
    s_waitcnt lgkmcnt(5)
    v_mfma_f32_32x32x16_bf16 v[128:143], v[16:19], v[48:51], v[128:143]
    ds_read_b128 v[32:35], v69 offset:36864
    ds_read_b64_tr_b16 v[56:57], v77 offset:20480
    s_waitcnt lgkmcnt(5)
    v_mfma_f32_32x32x16_bf16 v[144:159], v[16:19], v[52:55], v[144:159]
    ds_read_b64_tr_b16 v[58:59], v77 offset:21504
    ds_read_b64_tr_b16 v[60:61], v79 offset:20480
    s_waitcnt lgkmcnt(6)
    v_mfma_f32_32x32x16_bf16 v[160:175], v[20:23], v[48:51], v[160:175]
    ds_read_b64_tr_b16 v[62:63], v79 offset:21504
    ds_read_b128 v[36:39], v69 offset:40960
    v_mfma_f32_32x32x16_bf16 v[176:191], v[20:23], v[52:55], v[176:191]
    ds_read_b128 v[40:43], v69 offset:45056
    ds_read_b128 v[44:47], v69 offset:49152
    s_waitcnt lgkmcnt(9)
    v_mfma_f32_32x32x16_bf16 v[192:207], v[24:27], v[48:51], v[192:207]
    v_mfma_f32_32x32x16_bf16 v[208:223], v[24:27], v[52:55], v[208:223]
    s_waitcnt lgkmcnt(8)
    v_mfma_f32_32x32x16_bf16 v[224:239], v[28:31], v[48:51], v[224:239]
    v_mfma_f32_32x32x16_bf16 v[240:255], v[28:31], v[52:55], v[240:255]
    s_waitcnt lgkmcnt(5)
    v_mfma_f32_32x32x16_bf16 v[128:143], v[32:35], v[56:59], v[128:143]
    ds_read_b128 v[16:19], v70 offset:36864
    ds_read_b64_tr_b16 v[48:49], v77 offset:24576
    s_waitcnt lgkmcnt(5)
    v_mfma_f32_32x32x16_bf16 v[144:159], v[32:35], v[60:63], v[144:159]
    ds_read_b64_tr_b16 v[50:51], v77 offset:25600
    ds_read_b64_tr_b16 v[52:53], v79 offset:24576
    s_waitcnt lgkmcnt(6)
    v_mfma_f32_32x32x16_bf16 v[160:175], v[36:39], v[56:59], v[160:175]
    ds_read_b64_tr_b16 v[54:55], v79 offset:25600
    ds_read_b128 v[20:23], v70 offset:40960
    v_mfma_f32_32x32x16_bf16 v[176:191], v[36:39], v[60:63], v[176:191]
    ds_read_b128 v[24:27], v70 offset:45056
    ds_read_b128 v[28:31], v70 offset:49152
    s_waitcnt lgkmcnt(9)
    v_mfma_f32_32x32x16_bf16 v[192:207], v[40:43], v[56:59], v[192:207]
    v_mfma_f32_32x32x16_bf16 v[208:223], v[40:43], v[60:63], v[208:223]
    s_waitcnt lgkmcnt(8)
    v_mfma_f32_32x32x16_bf16 v[224:239], v[44:47], v[56:59], v[224:239]
    v_mfma_f32_32x32x16_bf16 v[240:255], v[44:47], v[60:63], v[240:255]
    s_waitcnt lgkmcnt(5)
    v_mfma_f32_32x32x16_bf16 v[128:143], v[16:19], v[48:51], v[128:143]
    ds_read_b128 v[32:35], v71 offset:36864
    ds_read_b64_tr_b16 v[56:57], v77 offset:28672
    s_waitcnt lgkmcnt(5)
    v_mfma_f32_32x32x16_bf16 v[144:159], v[16:19], v[52:55], v[144:159]
    ds_read_b64_tr_b16 v[58:59], v77 offset:29696
    ds_read_b64_tr_b16 v[60:61], v79 offset:28672
    s_waitcnt lgkmcnt(6)
    v_mfma_f32_32x32x16_bf16 v[160:175], v[20:23], v[48:51], v[160:175]
    ds_read_b64_tr_b16 v[62:63], v79 offset:29696
    ds_read_b128 v[36:39], v71 offset:40960
    v_mfma_f32_32x32x16_bf16 v[176:191], v[20:23], v[52:55], v[176:191]
    ds_read_b128 v[40:43], v71 offset:45056
    ds_read_b128 v[44:47], v71 offset:49152
    s_waitcnt lgkmcnt(9)
    v_mfma_f32_32x32x16_bf16 v[192:207], v[24:27], v[48:51], v[192:207]
    v_mfma_f32_32x32x16_bf16 v[208:223], v[24:27], v[52:55], v[208:223]
    s_waitcnt lgkmcnt(8)
    v_mfma_f32_32x32x16_bf16 v[224:239], v[28:31], v[48:51], v[224:239]
    v_mfma_f32_32x32x16_bf16 v[240:255], v[28:31], v[52:55], v[240:255]
    s_waitcnt lgkmcnt(5)
    v_mfma_f32_32x32x16_bf16 v[128:143], v[32:35], v[56:59], v[128:143]
    s_waitcnt lgkmcnt(3)
    v_mfma_f32_32x32x16_bf16 v[144:159], v[32:35], v[60:63], v[144:159]
    s_waitcnt lgkmcnt(2)
    v_mfma_f32_32x32x16_bf16 v[160:175], v[36:39], v[56:59], v[160:175]
    v_mfma_f32_32x32x16_bf16 v[176:191], v[36:39], v[60:63], v[176:191]
    s_waitcnt lgkmcnt(1)
    v_mfma_f32_32x32x16_bf16 v[192:207], v[40:43], v[56:59], v[192:207]
    v_mfma_f32_32x32x16_bf16 v[208:223], v[40:43], v[60:63], v[208:223]
    s_waitcnt lgkmcnt(0)
    v_mfma_f32_32x32x16_bf16 v[224:239], v[44:47], v[56:59], v[224:239]
    v_mfma_f32_32x32x16_bf16 v[240:255], v[44:47], v[60:63], v[240:255]
L_skiploop:
    s_nop 15
    s_nop 7
    s_mov_b32 s82, -1
    s_mov_b32 s83, 0
    s_cmp_eq_u32 s42, 31
    s_cbranch_scc1 L_st_part
    v_pk_add_f32 v[84:85], v[128:129], v[130:131]
    v_pk_add_f32 v[86:87], v[132:133], v[134:135]
    v_pk_add_f32 v[84:85], v[84:85], v[136:137]
    v_pk_add_f32 v[86:87], v[86:87], v[138:139]
    v_pk_add_f32 v[84:85], v[84:85], v[140:141]
    v_pk_add_f32 v[86:87], v[86:87], v[142:143]
    v_pk_add_f32 v[84:85], v[84:85], v[160:161]
    v_pk_add_f32 v[86:87], v[86:87], v[162:163]
    v_pk_add_f32 v[84:85], v[84:85], v[164:165]
    v_pk_add_f32 v[86:87], v[86:87], v[166:167]
    v_pk_add_f32 v[84:85], v[84:85], v[168:169]
    v_pk_add_f32 v[86:87], v[86:87], v[170:171]
    v_pk_add_f32 v[84:85], v[84:85], v[172:173]
    v_pk_add_f32 v[86:87], v[86:87], v[174:175]
    v_pk_add_f32 v[84:85], v[84:85], v[192:193]
    v_pk_add_f32 v[86:87], v[86:87], v[194:195]
    v_pk_add_f32 v[84:85], v[84:85], v[196:197]
    v_pk_add_f32 v[86:87], v[86:87], v[198:199]
    v_pk_add_f32 v[84:85], v[84:85], v[200:201]
    v_pk_add_f32 v[86:87], v[86:87], v[202:203]
    v_pk_add_f32 v[84:85], v[84:85], v[204:205]
    v_pk_add_f32 v[86:87], v[86:87], v[206:207]
    v_pk_add_f32 v[84:85], v[84:85], v[224:225]
    v_pk_add_f32 v[86:87], v[86:87], v[226:227]
    v_pk_add_f32 v[84:85], v[84:85], v[228:229]
    v_pk_add_f32 v[86:87], v[86:87], v[230:231]
    v_pk_add_f32 v[84:85], v[84:85], v[232:233]
    v_pk_add_f32 v[86:87], v[86:87], v[234:235]
    v_pk_add_f32 v[84:85], v[84:85], v[236:237]
    v_pk_add_f32 v[86:87], v[86:87], v[238:239]
    v_pk_add_f32 v[84:85], v[84:85], v[86:87]
    v_add_f32 v84, v84, v85
    v_mov_b32 v86, v84
    s_nop 1
    v_permlane32_swap_b32 v84, v86
    v_add_f32 v84, v84, v86
    s_mov_b32 s50, 0x3c000000
    v_mul_f32 v120, s50, v84
    v_mov_b32 v121, v120
    v_mov_b32 v84, 0
    v_mov_b32 v85, 0
    v_mov_b32 v86, 0
    v_mov_b32 v87, 0
    v_pk_add_f32 v[88:89], v[128:129], v[120:121] neg_lo:[0,1] neg_hi:[0,1]
    v_pk_add_f32 v[90:91], v[130:131], v[120:121] neg_lo:[0,1] neg_hi:[0,1]
    v_pk_fma_f32 v[84:85], v[88:89], v[88:89], v[84:85]
    v_pk_fma_f32 v[86:87], v[90:91], v[90:91], v[86:87]
    v_pk_add_f32 v[88:89], v[132:133], v[120:121] neg_lo:[0,1] neg_hi:[0,1]
    v_pk_add_f32 v[90:91], v[134:135], v[120:121] neg_lo:[0,1] neg_hi:[0,1]
    v_pk_fma_f32 v[84:85], v[88:89], v[88:89], v[84:85]
    v_pk_fma_f32 v[86:87], v[90:91], v[90:91], v[86:87]
    v_pk_add_f32 v[88:89], v[136:137], v[120:121] neg_lo:[0,1] neg_hi:[0,1]
    v_pk_add_f32 v[90:91], v[138:139], v[120:121] neg_lo:[0,1] neg_hi:[0,1]
    v_pk_fma_f32 v[84:85], v[88:89], v[88:89], v[84:85]
    v_pk_fma_f32 v[86:87], v[90:91], v[90:91], v[86:87]
    v_pk_add_f32 v[88:89], v[140:141], v[120:121] neg_lo:[0,1] neg_hi:[0,1]
    v_pk_add_f32 v[90:91], v[142:143], v[120:121] neg_lo:[0,1] neg_hi:[0,1]
    v_pk_fma_f32 v[84:85], v[88:89], v[88:89], v[84:85]
    v_pk_fma_f32 v[86:87], v[90:91], v[90:91], v[86:87]
    v_pk_add_f32 v[88:89], v[160:161], v[120:121] neg_lo:[0,1] neg_hi:[0,1]
    v_pk_add_f32 v[90:91], v[162:163], v[120:121] neg_lo:[0,1] neg_hi:[0,1]
    v_pk_fma_f32 v[84:85], v[88:89], v[88:89], v[84:85]
    v_pk_fma_f32 v[86:87], v[90:91], v[90:91], v[86:87]
    v_pk_add_f32 v[88:89], v[164:165], v[120:121] neg_lo:[0,1] neg_hi:[0,1]
    v_pk_add_f32 v[90:91], v[166:167], v[120:121] neg_lo:[0,1] neg_hi:[0,1]
    v_pk_fma_f32 v[84:85], v[88:89], v[88:89], v[84:85]
    v_pk_fma_f32 v[86:87], v[90:91], v[90:91], v[86:87]
    v_pk_add_f32 v[88:89], v[168:169], v[120:121] neg_lo:[0,1] neg_hi:[0,1]
    v_pk_add_f32 v[90:91], v[170:171], v[120:121] neg_lo:[0,1] neg_hi:[0,1]
    v_pk_fma_f32 v[84:85], v[88:89], v[88:89], v[84:85]
    v_pk_fma_f32 v[86:87], v[90:91], v[90:91], v[86:87]
    v_pk_add_f32 v[88:89], v[172:173], v[120:121] neg_lo:[0,1] neg_hi:[0,1]
    v_pk_add_f32 v[90:91], v[174:175], v[120:121] neg_lo:[0,1] neg_hi:[0,1]
    v_pk_fma_f32 v[84:85], v[88:89], v[88:89], v[84:85]
    v_pk_fma_f32 v[86:87], v[90:91], v[90:91], v[86:87]
    v_pk_add_f32 v[88:89], v[192:193], v[120:121] neg_lo:[0,1] neg_hi:[0,1]
    v_pk_add_f32 v[90:91], v[194:195], v[120:121] neg_lo:[0,1] neg_hi:[0,1]
    v_pk_fma_f32 v[84:85], v[88:89], v[88:89], v[84:85]
    v_pk_fma_f32 v[86:87], v[90:91], v[90:91], v[86:87]
    v_pk_add_f32 v[88:89], v[196:197], v[120:121] neg_lo:[0,1] neg_hi:[0,1]
    v_pk_add_f32 v[90:91], v[198:199], v[120:121] neg_lo:[0,1] neg_hi:[0,1]
    v_pk_fma_f32 v[84:85], v[88:89], v[88:89], v[84:85]
    v_pk_fma_f32 v[86:87], v[90:91], v[90:91], v[86:87]
    v_pk_add_f32 v[88:89], v[200:201], v[120:121] neg_lo:[0,1] neg_hi:[0,1]
    v_pk_add_f32 v[90:91], v[202:203], v[120:121] neg_lo:[0,1] neg_hi:[0,1]
    v_pk_fma_f32 v[84:85], v[88:89], v[88:89], v[84:85]
    v_pk_fma_f32 v[86:87], v[90:91], v[90:91], v[86:87]
    v_pk_add_f32 v[88:89], v[204:205], v[120:121] neg_lo:[0,1] neg_hi:[0,1]
    v_pk_add_f32 v[90:91], v[206:207], v[120:121] neg_lo:[0,1] neg_hi:[0,1]
    v_pk_fma_f32 v[84:85], v[88:89], v[88:89], v[84:85]
    v_pk_fma_f32 v[86:87], v[90:91], v[90:91], v[86:87]
    v_pk_add_f32 v[88:89], v[224:225], v[120:121] neg_lo:[0,1] neg_hi:[0,1]
    v_pk_add_f32 v[90:91], v[226:227], v[120:121] neg_lo:[0,1] neg_hi:[0,1]
    v_pk_fma_f32 v[84:85], v[88:89], v[88:89], v[84:85]
    v_pk_fma_f32 v[86:87], v[90:91], v[90:91], v[86:87]
    v_pk_add_f32 v[88:89], v[228:229], v[120:121] neg_lo:[0,1] neg_hi:[0,1]
    v_pk_add_f32 v[90:91], v[230:231], v[120:121] neg_lo:[0,1] neg_hi:[0,1]
    v_pk_fma_f32 v[84:85], v[88:89], v[88:89], v[84:85]
    v_pk_fma_f32 v[86:87], v[90:91], v[90:91], v[86:87]
    v_pk_add_f32 v[88:89], v[232:233], v[120:121] neg_lo:[0,1] neg_hi:[0,1]
    v_pk_add_f32 v[90:91], v[234:235], v[120:121] neg_lo:[0,1] neg_hi:[0,1]
    v_pk_fma_f32 v[84:85], v[88:89], v[88:89], v[84:85]
    v_pk_fma_f32 v[86:87], v[90:91], v[90:91], v[86:87]
    v_pk_add_f32 v[88:89], v[236:237], v[120:121] neg_lo:[0,1] neg_hi:[0,1]
    v_pk_add_f32 v[90:91], v[238:239], v[120:121] neg_lo:[0,1] neg_hi:[0,1]
    v_pk_fma_f32 v[84:85], v[88:89], v[88:89], v[84:85]
    v_pk_fma_f32 v[86:87], v[90:91], v[90:91], v[86:87]
    v_pk_add_f32 v[84:85], v[84:85], v[86:87]
    v_add_f32 v84, v84, v85
    v_mov_b32 v86, v84
    s_nop 1
    v_permlane32_swap_b32 v84, v86
    v_add_f32 v124, v84, v86
    v_pk_add_f32 v[84:85], v[144:145], v[146:147]
    v_pk_add_f32 v[86:87], v[148:149], v[150:151]
    v_pk_add_f32 v[84:85], v[84:85], v[152:153]
    v_pk_add_f32 v[86:87], v[86:87], v[154:155]
    v_pk_add_f32 v[84:85], v[84:85], v[156:157]
    v_pk_add_f32 v[86:87], v[86:87], v[158:159]
    v_pk_add_f32 v[84:85], v[84:85], v[176:177]
    v_pk_add_f32 v[86:87], v[86:87], v[178:179]
    v_pk_add_f32 v[84:85], v[84:85], v[180:181]
    v_pk_add_f32 v[86:87], v[86:87], v[182:183]
    v_pk_add_f32 v[84:85], v[84:85], v[184:185]
    v_pk_add_f32 v[86:87], v[86:87], v[186:187]
    v_pk_add_f32 v[84:85], v[84:85], v[188:189]
    v_pk_add_f32 v[86:87], v[86:87], v[190:191]
    v_pk_add_f32 v[84:85], v[84:85], v[208:209]
    v_pk_add_f32 v[86:87], v[86:87], v[210:211]
    v_pk_add_f32 v[84:85], v[84:85], v[212:213]
    v_pk_add_f32 v[86:87], v[86:87], v[214:215]
    v_pk_add_f32 v[84:85], v[84:85], v[216:217]
    v_pk_add_f32 v[86:87], v[86:87], v[218:219]
    v_pk_add_f32 v[84:85], v[84:85], v[220:221]
    v_pk_add_f32 v[86:87], v[86:87], v[222:223]
    v_pk_add_f32 v[84:85], v[84:85], v[240:241]
    v_pk_add_f32 v[86:87], v[86:87], v[242:243]
    v_pk_add_f32 v[84:85], v[84:85], v[244:245]
    v_pk_add_f32 v[86:87], v[86:87], v[246:247]
    v_pk_add_f32 v[84:85], v[84:85], v[248:249]
    v_pk_add_f32 v[86:87], v[86:87], v[250:251]
    v_pk_add_f32 v[84:85], v[84:85], v[252:253]
    v_pk_add_f32 v[86:87], v[86:87], v[254:255]
    v_pk_add_f32 v[84:85], v[84:85], v[86:87]
    v_add_f32 v84, v84, v85
    v_mov_b32 v86, v84
    s_nop 1
    v_permlane32_swap_b32 v84, v86
    v_add_f32 v84, v84, v86
    s_mov_b32 s50, 0x3c000000
    v_mul_f32 v122, s50, v84
    v_mov_b32 v123, v122
    v_mov_b32 v84, 0
    v_mov_b32 v85, 0
    v_mov_b32 v86, 0
    v_mov_b32 v87, 0
    v_pk_add_f32 v[88:89], v[144:145], v[122:123] neg_lo:[0,1] neg_hi:[0,1]
    v_pk_add_f32 v[90:91], v[146:147], v[122:123] neg_lo:[0,1] neg_hi:[0,1]
    v_pk_fma_f32 v[84:85], v[88:89], v[88:89], v[84:85]
    v_pk_fma_f32 v[86:87], v[90:91], v[90:91], v[86:87]
    v_pk_add_f32 v[88:89], v[148:149], v[122:123] neg_lo:[0,1] neg_hi:[0,1]
    v_pk_add_f32 v[90:91], v[150:151], v[122:123] neg_lo:[0,1] neg_hi:[0,1]
    v_pk_fma_f32 v[84:85], v[88:89], v[88:89], v[84:85]
    v_pk_fma_f32 v[86:87], v[90:91], v[90:91], v[86:87]
    v_pk_add_f32 v[88:89], v[152:153], v[122:123] neg_lo:[0,1] neg_hi:[0,1]
    v_pk_add_f32 v[90:91], v[154:155], v[122:123] neg_lo:[0,1] neg_hi:[0,1]
    v_pk_fma_f32 v[84:85], v[88:89], v[88:89], v[84:85]
    v_pk_fma_f32 v[86:87], v[90:91], v[90:91], v[86:87]
    v_pk_add_f32 v[88:89], v[156:157], v[122:123] neg_lo:[0,1] neg_hi:[0,1]
    v_pk_add_f32 v[90:91], v[158:159], v[122:123] neg_lo:[0,1] neg_hi:[0,1]
    v_pk_fma_f32 v[84:85], v[88:89], v[88:89], v[84:85]
    v_pk_fma_f32 v[86:87], v[90:91], v[90:91], v[86:87]
    v_pk_add_f32 v[88:89], v[176:177], v[122:123] neg_lo:[0,1] neg_hi:[0,1]
    v_pk_add_f32 v[90:91], v[178:179], v[122:123] neg_lo:[0,1] neg_hi:[0,1]
    v_pk_fma_f32 v[84:85], v[88:89], v[88:89], v[84:85]
    v_pk_fma_f32 v[86:87], v[90:91], v[90:91], v[86:87]
    v_pk_add_f32 v[88:89], v[180:181], v[122:123] neg_lo:[0,1] neg_hi:[0,1]
    v_pk_add_f32 v[90:91], v[182:183], v[122:123] neg_lo:[0,1] neg_hi:[0,1]
    v_pk_fma_f32 v[84:85], v[88:89], v[88:89], v[84:85]
    v_pk_fma_f32 v[86:87], v[90:91], v[90:91], v[86:87]
    v_pk_add_f32 v[88:89], v[184:185], v[122:123] neg_lo:[0,1] neg_hi:[0,1]
    v_pk_add_f32 v[90:91], v[186:187], v[122:123] neg_lo:[0,1] neg_hi:[0,1]
    v_pk_fma_f32 v[84:85], v[88:89], v[88:89], v[84:85]
    v_pk_fma_f32 v[86:87], v[90:91], v[90:91], v[86:87]
    v_pk_add_f32 v[88:89], v[188:189], v[122:123] neg_lo:[0,1] neg_hi:[0,1]
    v_pk_add_f32 v[90:91], v[190:191], v[122:123] neg_lo:[0,1] neg_hi:[0,1]
    v_pk_fma_f32 v[84:85], v[88:89], v[88:89], v[84:85]
    v_pk_fma_f32 v[86:87], v[90:91], v[90:91], v[86:87]
    v_pk_add_f32 v[88:89], v[208:209], v[122:123] neg_lo:[0,1] neg_hi:[0,1]
    v_pk_add_f32 v[90:91], v[210:211], v[122:123] neg_lo:[0,1] neg_hi:[0,1]
    v_pk_fma_f32 v[84:85], v[88:89], v[88:89], v[84:85]
    v_pk_fma_f32 v[86:87], v[90:91], v[90:91], v[86:87]
    v_pk_add_f32 v[88:89], v[212:213], v[122:123] neg_lo:[0,1] neg_hi:[0,1]
    v_pk_add_f32 v[90:91], v[214:215], v[122:123] neg_lo:[0,1] neg_hi:[0,1]
    v_pk_fma_f32 v[84:85], v[88:89], v[88:89], v[84:85]
    v_pk_fma_f32 v[86:87], v[90:91], v[90:91], v[86:87]
    v_pk_add_f32 v[88:89], v[216:217], v[122:123] neg_lo:[0,1] neg_hi:[0,1]
    v_pk_add_f32 v[90:91], v[218:219], v[122:123] neg_lo:[0,1] neg_hi:[0,1]
    v_pk_fma_f32 v[84:85], v[88:89], v[88:89], v[84:85]
    v_pk_fma_f32 v[86:87], v[90:91], v[90:91], v[86:87]
    v_pk_add_f32 v[88:89], v[220:221], v[122:123] neg_lo:[0,1] neg_hi:[0,1]
    v_pk_add_f32 v[90:91], v[222:223], v[122:123] neg_lo:[0,1] neg_hi:[0,1]
    v_pk_fma_f32 v[84:85], v[88:89], v[88:89], v[84:85]
    v_pk_fma_f32 v[86:87], v[90:91], v[90:91], v[86:87]
    v_pk_add_f32 v[88:89], v[240:241], v[122:123] neg_lo:[0,1] neg_hi:[0,1]
    v_pk_add_f32 v[90:91], v[242:243], v[122:123] neg_lo:[0,1] neg_hi:[0,1]
    v_pk_fma_f32 v[84:85], v[88:89], v[88:89], v[84:85]
    v_pk_fma_f32 v[86:87], v[90:91], v[90:91], v[86:87]
    v_pk_add_f32 v[88:89], v[244:245], v[122:123] neg_lo:[0,1] neg_hi:[0,1]
    v_pk_add_f32 v[90:91], v[246:247], v[122:123] neg_lo:[0,1] neg_hi:[0,1]
    v_pk_fma_f32 v[84:85], v[88:89], v[88:89], v[84:85]
    v_pk_fma_f32 v[86:87], v[90:91], v[90:91], v[86:87]
    v_pk_add_f32 v[88:89], v[248:249], v[122:123] neg_lo:[0,1] neg_hi:[0,1]
    v_pk_add_f32 v[90:91], v[250:251], v[122:123] neg_lo:[0,1] neg_hi:[0,1]
    v_pk_fma_f32 v[84:85], v[88:89], v[88:89], v[84:85]
    v_pk_fma_f32 v[86:87], v[90:91], v[90:91], v[86:87]
    v_pk_add_f32 v[88:89], v[252:253], v[122:123] neg_lo:[0,1] neg_hi:[0,1]
    v_pk_add_f32 v[90:91], v[254:255], v[122:123] neg_lo:[0,1] neg_hi:[0,1]
    v_pk_fma_f32 v[84:85], v[88:89], v[88:89], v[84:85]
    v_pk_fma_f32 v[86:87], v[90:91], v[90:91], v[86:87]
    v_pk_add_f32 v[84:85], v[84:85], v[86:87]
    v_add_f32 v84, v84, v85
    v_mov_b32 v86, v84
    s_nop 1
    v_permlane32_swap_b32 v84, v86
    v_add_f32 v126, v84, v86
    s_branch L_st_done
L_st_part:
    s_cmp_eq_u32 s39, 0
    s_cbranch_scc1 L_st_part0
    v_mov_b32 v120, 0
    v_mov_b32 v124, 0
    v_mov_b32 v122, 0
    v_mov_b32 v126, 0
    s_branch L_st_done
L_st_part0:
    v_mov_b32 v84, 0
    v_add_f32 v84, v84, v128
    v_add_f32 v84, v84, v129
    v_add_f32 v84, v84, v130
    v_add_f32 v84, v84, v131
    v_add_f32 v84, v84, v132
    v_add_f32 v84, v84, v133
    v_add_f32 v84, v84, v134
    v_add_f32 v84, v84, v135
    v_add_f32 v84, v84, v136
    v_add_f32 v84, v84, v137
    v_add_f32 v84, v84, v138
    v_add_f32 v84, v84, v139
    v_add_f32 v84, v84, v140
    v_add_f32 v84, v84, v141
    v_add_f32 v84, v84, v142
    v_add_f32 v84, v84, v143
    v_add_f32 v84, v84, v160
    v_add_f32 v84, v84, v161
    v_add_f32 v84, v84, v162
    v_add_f32 v84, v84, v163
    v_add_f32 v84, v84, v164
    v_add_f32 v84, v84, v165
    v_add_f32 v84, v84, v166
    v_add_f32 v84, v84, v167
    v_add_f32 v84, v84, v168
    v_add_f32 v84, v84, v169
    v_add_f32 v84, v84, v170
    v_add_f32 v84, v84, v171
    v_add_f32 v84, v84, v172
    v_add_f32 v84, v84, v173
    v_cndmask_b32 v88, 0, v174, s[82:83]
    v_add_f32 v84, v84, v88
    v_cndmask_b32 v88, 0, v175, s[82:83]
    v_add_f32 v84, v84, v88
    v_mov_b32 v86, v84
    s_nop 1
    v_permlane32_swap_b32 v84, v86
    v_add_f32 v84, v84, v86
    s_mov_b32 s50, 0x3c842108
    v_mul_f32 v120, s50, v84
    v_mov_b32 v121, v120
    v_mov_b32 v84, 0
    v_sub_f32 v88, v128, v120
    v_fmac_f32 v84, v88, v88
    v_sub_f32 v88, v129, v120
    v_fmac_f32 v84, v88, v88
    v_sub_f32 v88, v130, v120
    v_fmac_f32 v84, v88, v88
    v_sub_f32 v88, v131, v120
    v_fmac_f32 v84, v88, v88
    v_sub_f32 v88, v132, v120
    v_fmac_f32 v84, v88, v88
    v_sub_f32 v88, v133, v120
    v_fmac_f32 v84, v88, v88
    v_sub_f32 v88, v134, v120
    v_fmac_f32 v84, v88, v88
    v_sub_f32 v88, v135, v120
    v_fmac_f32 v84, v88, v88
    v_sub_f32 v88, v136, v120
    v_fmac_f32 v84, v88, v88
    v_sub_f32 v88, v137, v120
    v_fmac_f32 v84, v88, v88
    v_sub_f32 v88, v138, v120
    v_fmac_f32 v84, v88, v88
    v_sub_f32 v88, v139, v120
    v_fmac_f32 v84, v88, v88
    v_sub_f32 v88, v140, v120
    v_fmac_f32 v84, v88, v88
    v_sub_f32 v88, v141, v120
    v_fmac_f32 v84, v88, v88
    v_sub_f32 v88, v142, v120
    v_fmac_f32 v84, v88, v88
    v_sub_f32 v88, v143, v120
    v_fmac_f32 v84, v88, v88
    v_sub_f32 v88, v160, v120
    v_fmac_f32 v84, v88, v88
    v_sub_f32 v88, v161, v120
    v_fmac_f32 v84, v88, v88
    v_sub_f32 v88, v162, v120
    v_fmac_f32 v84, v88, v88
    v_sub_f32 v88, v163, v120
    v_fmac_f32 v84, v88, v88
    v_sub_f32 v88, v164, v120
    v_fmac_f32 v84, v88, v88
    v_sub_f32 v88, v165, v120
    v_fmac_f32 v84, v88, v88
    v_sub_f32 v88, v166, v120
    v_fmac_f32 v84, v88, v88
    v_sub_f32 v88, v167, v120
    v_fmac_f32 v84, v88, v88
    v_sub_f32 v88, v168, v120
    v_fmac_f32 v84, v88, v88
    v_sub_f32 v88, v169, v120
    v_fmac_f32 v84, v88, v88
    v_sub_f32 v88, v170, v120
    v_fmac_f32 v84, v88, v88
    v_sub_f32 v88, v171, v120
    v_fmac_f32 v84, v88, v88
    v_sub_f32 v88, v172, v120
    v_fmac_f32 v84, v88, v88
    v_sub_f32 v88, v173, v120
    v_fmac_f32 v84, v88, v88
    v_sub_f32 v88, v174, v120
    v_cndmask_b32 v88, 0, v88, s[82:83]
    v_fmac_f32 v84, v88, v88
    v_sub_f32 v88, v175, v120
    v_cndmask_b32 v88, 0, v88, s[82:83]
    v_fmac_f32 v84, v88, v88
    v_mov_b32 v86, v84
    s_nop 1
    v_permlane32_swap_b32 v84, v86
    v_add_f32 v124, v84, v86
    v_mov_b32 v84, 0
    v_add_f32 v84, v84, v144
    v_add_f32 v84, v84, v145
    v_add_f32 v84, v84, v146
    v_add_f32 v84, v84, v147
    v_add_f32 v84, v84, v148
    v_add_f32 v84, v84, v149
    v_add_f32 v84, v84, v150
    v_add_f32 v84, v84, v151
    v_add_f32 v84, v84, v152
    v_add_f32 v84, v84, v153
    v_add_f32 v84, v84, v154
    v_add_f32 v84, v84, v155
    v_add_f32 v84, v84, v156
    v_add_f32 v84, v84, v157
    v_add_f32 v84, v84, v158
    v_add_f32 v84, v84, v159
    v_add_f32 v84, v84, v176
    v_add_f32 v84, v84, v177
    v_add_f32 v84, v84, v178
    v_add_f32 v84, v84, v179
    v_add_f32 v84, v84, v180
    v_add_f32 v84, v84, v181
    v_add_f32 v84, v84, v182
    v_add_f32 v84, v84, v183
    v_add_f32 v84, v84, v184
    v_add_f32 v84, v84, v185
    v_add_f32 v84, v84, v186
    v_add_f32 v84, v84, v187
    v_add_f32 v84, v84, v188
    v_add_f32 v84, v84, v189
    v_cndmask_b32 v88, 0, v190, s[82:83]
    v_add_f32 v84, v84, v88
    v_cndmask_b32 v88, 0, v191, s[82:83]
    v_add_f32 v84, v84, v88
    v_mov_b32 v86, v84
    s_nop 1
    v_permlane32_swap_b32 v84, v86
    v_add_f32 v84, v84, v86
    s_mov_b32 s50, 0x3c842108
    v_mul_f32 v122, s50, v84
    v_mov_b32 v123, v122
    v_mov_b32 v84, 0
    v_sub_f32 v88, v144, v122
    v_fmac_f32 v84, v88, v88
    v_sub_f32 v88, v145, v122
    v_fmac_f32 v84, v88, v88
    v_sub_f32 v88, v146, v122
    v_fmac_f32 v84, v88, v88
    v_sub_f32 v88, v147, v122
    v_fmac_f32 v84, v88, v88
    v_sub_f32 v88, v148, v122
    v_fmac_f32 v84, v88, v88
    v_sub_f32 v88, v149, v122
    v_fmac_f32 v84, v88, v88
    v_sub_f32 v88, v150, v122
    v_fmac_f32 v84, v88, v88
    v_sub_f32 v88, v151, v122
    v_fmac_f32 v84, v88, v88
    v_sub_f32 v88, v152, v122
    v_fmac_f32 v84, v88, v88
    v_sub_f32 v88, v153, v122
    v_fmac_f32 v84, v88, v88
    v_sub_f32 v88, v154, v122
    v_fmac_f32 v84, v88, v88
    v_sub_f32 v88, v155, v122
    v_fmac_f32 v84, v88, v88
    v_sub_f32 v88, v156, v122
    v_fmac_f32 v84, v88, v88
    v_sub_f32 v88, v157, v122
    v_fmac_f32 v84, v88, v88
    v_sub_f32 v88, v158, v122
    v_fmac_f32 v84, v88, v88
    v_sub_f32 v88, v159, v122
    v_fmac_f32 v84, v88, v88
    v_sub_f32 v88, v176, v122
    v_fmac_f32 v84, v88, v88
    v_sub_f32 v88, v177, v122
    v_fmac_f32 v84, v88, v88
    v_sub_f32 v88, v178, v122
    v_fmac_f32 v84, v88, v88
    v_sub_f32 v88, v179, v122
    v_fmac_f32 v84, v88, v88
    v_sub_f32 v88, v180, v122
    v_fmac_f32 v84, v88, v88
    v_sub_f32 v88, v181, v122
    v_fmac_f32 v84, v88, v88
    v_sub_f32 v88, v182, v122
    v_fmac_f32 v84, v88, v88
    v_sub_f32 v88, v183, v122
    v_fmac_f32 v84, v88, v88
    v_sub_f32 v88, v184, v122
    v_fmac_f32 v84, v88, v88
    v_sub_f32 v88, v185, v122
    v_fmac_f32 v84, v88, v88
    v_sub_f32 v88, v186, v122
    v_fmac_f32 v84, v88, v88
    v_sub_f32 v88, v187, v122
    v_fmac_f32 v84, v88, v88
    v_sub_f32 v88, v188, v122
    v_fmac_f32 v84, v88, v88
    v_sub_f32 v88, v189, v122
    v_fmac_f32 v84, v88, v88
    v_sub_f32 v88, v190, v122
    v_cndmask_b32 v88, 0, v88, s[82:83]
    v_fmac_f32 v84, v88, v88
    v_sub_f32 v88, v191, v122
    v_cndmask_b32 v88, 0, v88, s[82:83]
    v_fmac_f32 v84, v88, v88
    v_mov_b32 v86, v84
    s_nop 1
    v_permlane32_swap_b32 v84, v86
    v_add_f32 v126, v84, v86
L_st_done:
    s_lshl_b32 s50, s41, 6
    s_lshl_b32 s51, s42, 1
    s_add_u32 s50, s50, s51
    s_add_u32 s50, s50, s39
    s_lshl_b32 s50, s50, 12
    s_lshl_b32 s51, s40, 6
    s_add_u32 s51, s51, s44
    v_and_b32 v2, 31, v1
    v_add_u32 v2, s51, v2
    v_lshlrev_b32 v2, 3, v2
    v_mov_b32 v84, v120
    v_mov_b32 v85, v124
    buffer_store_dwordx2 v[84:85], v2, s[20:23], s50 offen offset:0 sc0 sc1
    v_mov_b32 v86, v122
    v_mov_b32 v87, v126
    buffer_store_dwordx2 v[86:87], v2, s[20:23], s50 offen offset:256 sc0 sc1
    s_waitcnt vmcnt(0)
    s_barrier
    s_cmp_lg_u32 s38, 0
    s_cbranch_scc1 L_gb_arrived
    v_mov_b32 v84, s36
    v_mov_b32 v85, s37
    v_mov_b32 v86, 1
    v_cmp_eq_u32 vcc, 0, v1
    s_and_saveexec_b64 s[52:53], vcc
    global_atomic_add v[84:85], v86, off sc1
    s_mov_b64 exec, s[52:53]
L_gb_arrived:
    s_lshl_b32 s50, s38, 15
    v_lshrrev_b32 v2, 5, v1
    v_lshlrev_b32 v2, 10, v2
    v_and_b32 v3, 31, v1
    v_lshl_add_u32 v2, v3, 2, v2
    v_add_u32 v6, s50, v2
    v_lshlrev_b32 v2, 5, v1
    v_add_u32 v7, s50, v2
    ds_write_b32 v6, v128 offset:0
    ds_write_b32 v6, v129 offset:256
    ds_write_b32 v6, v130 offset:512
    ds_write_b32 v6, v131 offset:768
    ds_write_b32 v6, v132 offset:2048
    ds_write_b32 v6, v133 offset:2304
    ds_write_b32 v6, v134 offset:2560
    ds_write_b32 v6, v135 offset:2816
    ds_write_b32 v6, v136 offset:4096
    ds_write_b32 v6, v137 offset:4352
    ds_write_b32 v6, v138 offset:4608
    ds_write_b32 v6, v139 offset:4864
    ds_write_b32 v6, v140 offset:6144
    ds_write_b32 v6, v141 offset:6400
    ds_write_b32 v6, v142 offset:6656
    ds_write_b32 v6, v143 offset:6912
    ds_write_b32 v6, v144 offset:128
    ds_write_b32 v6, v145 offset:384
    ds_write_b32 v6, v146 offset:640
    ds_write_b32 v6, v147 offset:896
    ds_write_b32 v6, v148 offset:2176
    ds_write_b32 v6, v149 offset:2432
    ds_write_b32 v6, v150 offset:2688
    ds_write_b32 v6, v151 offset:2944
    ds_write_b32 v6, v152 offset:4224
    ds_write_b32 v6, v153 offset:4480
    ds_write_b32 v6, v154 offset:4736
    ds_write_b32 v6, v155 offset:4992
    ds_write_b32 v6, v156 offset:6272
    ds_write_b32 v6, v157 offset:6528
    ds_write_b32 v6, v158 offset:6784
    ds_write_b32 v6, v159 offset:7040
    ds_write_b32 v6, v160 offset:8192
    ds_write_b32 v6, v161 offset:8448
    ds_write_b32 v6, v162 offset:8704
    ds_write_b32 v6, v163 offset:8960
    ds_write_b32 v6, v164 offset:10240
    ds_write_b32 v6, v165 offset:10496
    ds_write_b32 v6, v166 offset:10752
    ds_write_b32 v6, v167 offset:11008
    ds_write_b32 v6, v168 offset:12288
    ds_write_b32 v6, v169 offset:12544
    ds_write_b32 v6, v170 offset:12800
    ds_write_b32 v6, v171 offset:13056
    ds_write_b32 v6, v172 offset:14336
    ds_write_b32 v6, v173 offset:14592
    ds_write_b32 v6, v174 offset:14848
    ds_write_b32 v6, v175 offset:15104
    ds_write_b32 v6, v176 offset:8320
    ds_write_b32 v6, v177 offset:8576
    ds_write_b32 v6, v178 offset:8832
    ds_write_b32 v6, v179 offset:9088
    ds_write_b32 v6, v180 offset:10368
    ds_write_b32 v6, v181 offset:10624
    ds_write_b32 v6, v182 offset:10880
    ds_write_b32 v6, v183 offset:11136
    ds_write_b32 v6, v184 offset:12416
    ds_write_b32 v6, v185 offset:12672
    ds_write_b32 v6, v186 offset:12928
    ds_write_b32 v6, v187 offset:13184
    ds_write_b32 v6, v188 offset:14464
    ds_write_b32 v6, v189 offset:14720
    ds_write_b32 v6, v190 offset:14976
    ds_write_b32 v6, v191 offset:15232
    ds_write_b32 v6, v192 offset:16384
    ds_write_b32 v6, v193 offset:16640
    ds_write_b32 v6, v194 offset:16896
    ds_write_b32 v6, v195 offset:17152
    ds_write_b32 v6, v196 offset:18432
    ds_write_b32 v6, v197 offset:18688
    ds_write_b32 v6, v198 offset:18944
    ds_write_b32 v6, v199 offset:19200
    ds_write_b32 v6, v200 offset:20480
    ds_write_b32 v6, v201 offset:20736
    ds_write_b32 v6, v202 offset:20992
    ds_write_b32 v6, v203 offset:21248
    ds_write_b32 v6, v204 offset:22528
    ds_write_b32 v6, v205 offset:22784
    ds_write_b32 v6, v206 offset:23040
    ds_write_b32 v6, v207 offset:23296
    ds_write_b32 v6, v208 offset:16512
    ds_write_b32 v6, v209 offset:16768
    ds_write_b32 v6, v210 offset:17024
    ds_write_b32 v6, v211 offset:17280
    ds_write_b32 v6, v212 offset:18560
    ds_write_b32 v6, v213 offset:18816
    ds_write_b32 v6, v214 offset:19072
    ds_write_b32 v6, v215 offset:19328
    ds_write_b32 v6, v216 offset:20608
    ds_write_b32 v6, v217 offset:20864
    ds_write_b32 v6, v218 offset:21120
    ds_write_b32 v6, v219 offset:21376
    ds_write_b32 v6, v220 offset:22656
    ds_write_b32 v6, v221 offset:22912
    ds_write_b32 v6, v222 offset:23168
    ds_write_b32 v6, v223 offset:23424
    ds_write_b32 v6, v224 offset:24576
    ds_write_b32 v6, v225 offset:24832
    ds_write_b32 v6, v226 offset:25088
    ds_write_b32 v6, v227 offset:25344
    ds_write_b32 v6, v228 offset:26624
    ds_write_b32 v6, v229 offset:26880
    ds_write_b32 v6, v230 offset:27136
    ds_write_b32 v6, v231 offset:27392
    ds_write_b32 v6, v232 offset:28672
    ds_write_b32 v6, v233 offset:28928
    ds_write_b32 v6, v234 offset:29184
    ds_write_b32 v6, v235 offset:29440
    ds_write_b32 v6, v236 offset:30720
    ds_write_b32 v6, v237 offset:30976
    ds_write_b32 v6, v238 offset:31232
    ds_write_b32 v6, v239 offset:31488
    ds_write_b32 v6, v240 offset:24704
    ds_write_b32 v6, v241 offset:24960
    ds_write_b32 v6, v242 offset:25216
    ds_write_b32 v6, v243 offset:25472
    ds_write_b32 v6, v244 offset:26752
    ds_write_b32 v6, v245 offset:27008
    ds_write_b32 v6, v246 offset:27264
    ds_write_b32 v6, v247 offset:27520
    ds_write_b32 v6, v248 offset:28800
    ds_write_b32 v6, v249 offset:29056
    ds_write_b32 v6, v250 offset:29312
    ds_write_b32 v6, v251 offset:29568
    ds_write_b32 v6, v252 offset:30848
    ds_write_b32 v6, v253 offset:31104
    ds_write_b32 v6, v254 offset:31360
    ds_write_b32 v6, v255 offset:31616
    ds_read_b128 v[128:131], v7 offset:0
    ds_read_b128 v[132:135], v7 offset:16
    ds_read_b128 v[136:139], v7 offset:2048
    ds_read_b128 v[140:143], v7 offset:2064
    ds_read_b128 v[144:147], v7 offset:4096
    ds_read_b128 v[148:151], v7 offset:4112
    ds_read_b128 v[152:155], v7 offset:6144
    ds_read_b128 v[156:159], v7 offset:6160
    ds_read_b128 v[160:163], v7 offset:8192
    ds_read_b128 v[164:167], v7 offset:8208
    ds_read_b128 v[168:171], v7 offset:10240
    ds_read_b128 v[172:175], v7 offset:10256
    ds_read_b128 v[176:179], v7 offset:12288
    ds_read_b128 v[180:183], v7 offset:12304
    ds_read_b128 v[184:187], v7 offset:14336
    ds_read_b128 v[188:191], v7 offset:14352
    ds_read_b128 v[192:195], v7 offset:16384
    ds_read_b128 v[196:199], v7 offset:16400
    ds_read_b128 v[200:203], v7 offset:18432
    ds_read_b128 v[204:207], v7 offset:18448
    ds_read_b128 v[208:211], v7 offset:20480
    ds_read_b128 v[212:215], v7 offset:20496
    ds_read_b128 v[216:219], v7 offset:22528
    ds_read_b128 v[220:223], v7 offset:22544
    ds_read_b128 v[224:227], v7 offset:24576
    ds_read_b128 v[228:231], v7 offset:24592
    ds_read_b128 v[232:235], v7 offset:26624
    ds_read_b128 v[236:239], v7 offset:26640
    ds_read_b128 v[240:243], v7 offset:28672
    ds_read_b128 v[244:247], v7 offset:28688
    ds_read_b128 v[248:251], v7 offset:30720
    ds_read_b128 v[252:255], v7 offset:30736
    s_cmp_lg_u32 s38, 0
    s_cbranch_scc1 L_gb_done
    s_mov_b32 s50, 0
L_gb_poll:
    global_load_dword v86, v[84:85], off sc0 sc1
    s_waitcnt vmcnt(0)
    v_readfirstlane_b32 s51, v86
    s_add_u32 s50, s50, 1
    s_cmp_ge_u32 s51, 256
    s_cbranch_scc1 L_gb_done
    s_cmp_ge_u32 s50, 2000000
    s_cbranch_scc1 L_gb_done
    s_sleep 2
    s_branch L_gb_poll
L_gb_done:
    s_barrier
    s_lshl_b32 s50, s39, 6
    s_add_u32 s50, s50, s44
    v_add_u32 v2, s50, v1
    v_lshlrev_b32 v3, 1, v2
    buffer_load_ushort v82, v3, s[28:31], 0 offen
    buffer_load_ushort v83, v3, s[32:35], 0 offen
    v_lshlrev_b32 v2, 3, v2
    s_lshl_b32 s50, s41, 6
    s_lshl_b32 s51, s40, 5
    s_add_u32 s50, s50, s51
    s_lshl_b32 s50, s50, 12
    buffer_load_dwordx2 v[16:17], v2, s[20:23], s50 offen sc0 sc1
    s_add_u32 s50, s50, 4096
    buffer_load_dwordx2 v[18:19], v2, s[20:23], s50 offen sc0 sc1
    s_add_u32 s50, s50, 4096
    buffer_load_dwordx2 v[20:21], v2, s[20:23], s50 offen sc0 sc1
    s_add_u32 s50, s50, 4096
    buffer_load_dwordx2 v[22:23], v2, s[20:23], s50 offen sc0 sc1
    s_add_u32 s50, s50, 4096
    buffer_load_dwordx2 v[24:25], v2, s[20:23], s50 offen sc0 sc1
    s_add_u32 s50, s50, 4096
    buffer_load_dwordx2 v[26:27], v2, s[20:23], s50 offen sc0 sc1
    s_add_u32 s50, s50, 4096
    buffer_load_dwordx2 v[28:29], v2, s[20:23], s50 offen sc0 sc1
    s_add_u32 s50, s50, 4096
    buffer_load_dwordx2 v[30:31], v2, s[20:23], s50 offen sc0 sc1
    s_add_u32 s50, s50, 4096
    buffer_load_dwordx2 v[32:33], v2, s[20:23], s50 offen sc0 sc1
    s_add_u32 s50, s50, 4096
    buffer_load_dwordx2 v[34:35], v2, s[20:23], s50 offen sc0 sc1
    s_add_u32 s50, s50, 4096
    buffer_load_dwordx2 v[36:37], v2, s[20:23], s50 offen sc0 sc1
    s_add_u32 s50, s50, 4096
    buffer_load_dwordx2 v[38:39], v2, s[20:23], s50 offen sc0 sc1
    s_add_u32 s50, s50, 4096
    buffer_load_dwordx2 v[40:41], v2, s[20:23], s50 offen sc0 sc1
    s_add_u32 s50, s50, 4096
    buffer_load_dwordx2 v[42:43], v2, s[20:23], s50 offen sc0 sc1
    s_add_u32 s50, s50, 4096
    buffer_load_dwordx2 v[44:45], v2, s[20:23], s50 offen sc0 sc1
    s_add_u32 s50, s50, 4096
    buffer_load_dwordx2 v[46:47], v2, s[20:23], s50 offen sc0 sc1
    s_add_u32 s50, s50, 4096
    buffer_load_dwordx2 v[48:49], v2, s[20:23], s50 offen sc0 sc1
    s_add_u32 s50, s50, 4096
    buffer_load_dwordx2 v[50:51], v2, s[20:23], s50 offen sc0 sc1
    s_add_u32 s50, s50, 4096
    buffer_load_dwordx2 v[52:53], v2, s[20:23], s50 offen sc0 sc1
    s_add_u32 s50, s50, 4096
    buffer_load_dwordx2 v[54:55], v2, s[20:23], s50 offen sc0 sc1
    s_add_u32 s50, s50, 4096
    buffer_load_dwordx2 v[56:57], v2, s[20:23], s50 offen sc0 sc1
    s_add_u32 s50, s50, 4096
    buffer_load_dwordx2 v[58:59], v2, s[20:23], s50 offen sc0 sc1
    s_add_u32 s50, s50, 4096
    buffer_load_dwordx2 v[60:61], v2, s[20:23], s50 offen sc0 sc1
    s_add_u32 s50, s50, 4096
    buffer_load_dwordx2 v[62:63], v2, s[20:23], s50 offen sc0 sc1
    s_add_u32 s50, s50, 4096
    buffer_load_dwordx2 v[64:65], v2, s[20:23], s50 offen sc0 sc1
    s_add_u32 s50, s50, 4096
    buffer_load_dwordx2 v[66:67], v2, s[20:23], s50 offen sc0 sc1
    s_add_u32 s50, s50, 4096
    buffer_load_dwordx2 v[68:69], v2, s[20:23], s50 offen sc0 sc1
    s_add_u32 s50, s50, 4096
    buffer_load_dwordx2 v[70:71], v2, s[20:23], s50 offen sc0 sc1
    s_add_u32 s50, s50, 4096
    buffer_load_dwordx2 v[72:73], v2, s[20:23], s50 offen sc0 sc1
    s_add_u32 s50, s50, 4096
    buffer_load_dwordx2 v[74:75], v2, s[20:23], s50 offen sc0 sc1
    s_add_u32 s50, s50, 4096
    buffer_load_dwordx2 v[76:77], v2, s[20:23], s50 offen sc0 sc1
    s_add_u32 s50, s50, 4096
    buffer_load_dwordx2 v[78:79], v2, s[20:23], s50 offen sc0 sc1
    s_add_u32 s50, s50, 4096
    s_mov_b32 s52, 0x43000000
    s_mov_b32 s53, 0x42780000
    s_cmp_eq_u32 s40, 0
    s_cselect_b32 s50, s52, s53
    s_cselect_b32 s51, s52, 0
    v_mov_b32 v92, s50
    v_mov_b32 v93, s51
    s_lshl_b32 s50, s39, 6
    v_add_u32 v4, s50, v1
    v_lshlrev_b32 v4, 2, v4
    s_lshl_b32 s50, s40, 9
    s_add_u32 s50, s50, 131072
    v_add_u32 v94, s50, v4
    s_xor_b32 s50, s40, 1
    s_lshl_b32 s50, s50, 9
    s_add_u32 s50, s50, 131072
    v_add_u32 v95, s50, v4
    s_waitcnt vmcnt(0)
    v_mov_b32 v84, v16
    v_add_f32 v84, v84, v18
    v_add_f32 v84, v84, v20
    v_add_f32 v84, v84, v22
    v_add_f32 v84, v84, v24
    v_add_f32 v84, v84, v26
    v_add_f32 v84, v84, v28
    v_add_f32 v84, v84, v30
    v_add_f32 v84, v84, v32
    v_add_f32 v84, v84, v34
    v_add_f32 v84, v84, v36
    v_add_f32 v84, v84, v38
    v_add_f32 v84, v84, v40
    v_add_f32 v84, v84, v42
    v_add_f32 v84, v84, v44
    v_add_f32 v84, v84, v46
    v_add_f32 v84, v84, v48
    v_add_f32 v84, v84, v50
    v_add_f32 v84, v84, v52
    v_add_f32 v84, v84, v54
    v_add_f32 v84, v84, v56
    v_add_f32 v84, v84, v58
    v_add_f32 v84, v84, v60
    v_add_f32 v84, v84, v62
    v_add_f32 v84, v84, v64
    v_add_f32 v84, v84, v66
    v_add_f32 v84, v84, v68
    v_add_f32 v84, v84, v70
    v_add_f32 v84, v84, v72
    v_add_f32 v84, v84, v74
    v_mul_f32 v84, 0x43000000, v84
    v_fmac_f32 v84, v92, v76
    v_fmac_f32 v84, v93, v78
    ds_write_b32 v94, v84
    s_waitcnt lgkmcnt(0)
    s_barrier
    ds_read_b32 v85, v95
    s_waitcnt lgkmcnt(0)
    v_add_f32 v84, v84, v85
    v_mul_f32 v86, 0x39031ad3, v84
    v_mov_b32 v87, 0
    v_sub_f32 v88, v16, v86
    v_fmac_f32 v87, v88, v88
    v_sub_f32 v88, v18, v86
    v_fmac_f32 v87, v88, v88
    v_sub_f32 v88, v20, v86
    v_fmac_f32 v87, v88, v88
    v_sub_f32 v88, v22, v86
    v_fmac_f32 v87, v88, v88
    v_sub_f32 v88, v24, v86
    v_fmac_f32 v87, v88, v88
    v_sub_f32 v88, v26, v86
    v_fmac_f32 v87, v88, v88
    v_sub_f32 v88, v28, v86
    v_fmac_f32 v87, v88, v88
    v_sub_f32 v88, v30, v86
    v_fmac_f32 v87, v88, v88
    v_sub_f32 v88, v32, v86
    v_fmac_f32 v87, v88, v88
    v_sub_f32 v88, v34, v86
    v_fmac_f32 v87, v88, v88
    v_sub_f32 v88, v36, v86
    v_fmac_f32 v87, v88, v88
    v_sub_f32 v88, v38, v86
    v_fmac_f32 v87, v88, v88
    v_sub_f32 v88, v40, v86
    v_fmac_f32 v87, v88, v88
    v_sub_f32 v88, v42, v86
    v_fmac_f32 v87, v88, v88
    v_sub_f32 v88, v44, v86
    v_fmac_f32 v87, v88, v88
    v_sub_f32 v88, v46, v86
    v_fmac_f32 v87, v88, v88
    v_sub_f32 v88, v48, v86
    v_fmac_f32 v87, v88, v88
    v_sub_f32 v88, v50, v86
    v_fmac_f32 v87, v88, v88
    v_sub_f32 v88, v52, v86
    v_fmac_f32 v87, v88, v88
    v_sub_f32 v88, v54, v86
    v_fmac_f32 v87, v88, v88
    v_sub_f32 v88, v56, v86
    v_fmac_f32 v87, v88, v88
    v_sub_f32 v88, v58, v86
    v_fmac_f32 v87, v88, v88
    v_sub_f32 v88, v60, v86
    v_fmac_f32 v87, v88, v88
    v_sub_f32 v88, v62, v86
    v_fmac_f32 v87, v88, v88
    v_sub_f32 v88, v64, v86
    v_fmac_f32 v87, v88, v88
    v_sub_f32 v88, v66, v86
    v_fmac_f32 v87, v88, v88
    v_sub_f32 v88, v68, v86
    v_fmac_f32 v87, v88, v88
    v_sub_f32 v88, v70, v86
    v_fmac_f32 v87, v88, v88
    v_sub_f32 v88, v72, v86
    v_fmac_f32 v87, v88, v88
    v_sub_f32 v88, v74, v86
    v_fmac_f32 v87, v88, v88
    v_mul_f32 v87, 0x43000000, v87
    v_sub_f32 v88, v76, v86
    v_mul_f32 v88, v88, v88
    v_fmac_f32 v87, v92, v88
    v_sub_f32 v88, v78, v86
    v_mul_f32 v88, v88, v88
    v_fmac_f32 v87, v93, v88
    v_add_f32 v87, v87, v17
    v_add_f32 v87, v87, v19
    v_add_f32 v87, v87, v21
    v_add_f32 v87, v87, v23
    v_add_f32 v87, v87, v25
    v_add_f32 v87, v87, v27
    v_add_f32 v87, v87, v29
    v_add_f32 v87, v87, v31
    v_add_f32 v87, v87, v33
    v_add_f32 v87, v87, v35
    v_add_f32 v87, v87, v37
    v_add_f32 v87, v87, v39
    v_add_f32 v87, v87, v41
    v_add_f32 v87, v87, v43
    v_add_f32 v87, v87, v45
    v_add_f32 v87, v87, v47
    v_add_f32 v87, v87, v49
    v_add_f32 v87, v87, v51
    v_add_f32 v87, v87, v53
    v_add_f32 v87, v87, v55
    v_add_f32 v87, v87, v57
    v_add_f32 v87, v87, v59
    v_add_f32 v87, v87, v61
    v_add_f32 v87, v87, v63
    v_add_f32 v87, v87, v65
    v_add_f32 v87, v87, v67
    v_add_f32 v87, v87, v69
    v_add_f32 v87, v87, v71
    v_add_f32 v87, v87, v73
    v_add_f32 v87, v87, v75
    v_add_f32 v87, v87, v77
    v_add_f32 v87, v87, v79
    s_barrier
    ds_write_b32 v94, v87
    s_waitcnt lgkmcnt(0)
    s_barrier
    ds_read_b32 v85, v95
    s_waitcnt lgkmcnt(0)
    v_add_f32 v87, v87, v85
    v_mov_b32 v88, 0x3727c5ac
    v_fmac_f32 v88, 0x39031ad3, v87
    v_rsq_f32 v88, v88
    v_lshlrev_b32 v82, 16, v82
    v_lshlrev_b32 v83, 16, v83
    v_mul_f32 v88, v88, v82
    v_add_u32 v5, 132096, v4
    ds_write_b32 v5, v86
    ds_write_b32 v5, v88 offset:512
    ds_write_b32 v5, v83 offset:1024
    s_waitcnt lgkmcnt(0)
    s_barrier
    s_lshl_b32 s50, s40, 8
    v_and_b32 v2, 7, v1
    v_lshlrev_b32 v2, 5, v2
    v_add_u32 v2, s50, v2
    v_add_u32 v2, 132096, v2
    ds_read_b128 v[16:19], v2 offset:0
    ds_read_b128 v[20:23], v2 offset:16
    ds_read_b128 v[24:27], v2 offset:512
    ds_read_b128 v[28:31], v2 offset:528
    ds_read_b128 v[32:35], v2 offset:1024
    ds_read_b128 v[36:39], v2 offset:1040
    v_mov_b32 v40, 0xbdd2d3e8
    v_mov_b32 v41, 0xbdd2d3e8
    v_mov_b32 v42, 0xc0135761
    v_mov_b32 v43, 0xc0135761
    v_mov_b32 v44, 1.0
    v_mov_b32 v45, 1.0
    s_lshl_b32 s50, s38, 14
    v_lshrrev_b32 v2, 5, v1
    v_lshlrev_b32 v2, 9, v2
    v_and_b32 v3, 31, v1
    v_lshl_add_u32 v2, v3, 1, v2
    v_add_u32 v6, s50, v2
    v_lshlrev_b32 v2, 4, v1
    v_add_u32 v7, s50, v2
    s_mul_i32 s50, s41, 7998
    s_add_u32 s50, s50, s43
    s_lshl_b32 s51, s39, 7
    s_add_u32 s50, s50, s51
    s_add_u32 s52, s43, s51
    s_lshl_b32 s50, s50, 10
    s_lshl_b32 s51, s40, 6
    s_add_u32 s51, s51, s44
    s_lshl_b32 s51, s51, 1
    s_add_u32 s50, s50, s51
    v_lshrrev_b32 v2, 3, v1
    v_add_u32 v9, s52, v2
    v_lshlrev_b32 v2, 10, v2
    v_and_b32 v3, 7, v1
    v_lshl_add_u32 v2, v3, 4, v2
    v_add_u32 v8, s50, v2
    v_mov_b32 v5, 0x7ffffff0
    s_waitcnt lgkmcnt(0)
    v_sub_f32 v16, 0, v16
    v_sub_f32 v17, 0, v17
    v_sub_f32 v18, 0, v18
    v_sub_f32 v19, 0, v19
    v_sub_f32 v20, 0, v20
    v_sub_f32 v21, 0, v21
    v_sub_f32 v22, 0, v22
    v_sub_f32 v23, 0, v23
    v_pk_add_f32 v[46:47], v[128:129], v[16:17]
    v_pk_add_f32 v[52:53], v[130:131], v[18:19]
    v_pk_fma_f32 v[46:47], v[46:47], v[24:25], v[32:33]
    v_pk_fma_f32 v[52:53], v[52:53], v[26:27], v[34:35]
    v_pk_mul_f32 v[48:49], v[46:47], v[46:47]
    v_pk_mul_f32 v[54:55], v[52:53], v[52:53]
    v_pk_fma_f32 v[48:49], v[48:49], v[40:41], v[42:43]
    v_pk_fma_f32 v[54:55], v[54:55], v[40:41], v[42:43]
    v_pk_mul_f32 v[48:49], v[46:47], v[48:49]
    v_pk_mul_f32 v[54:55], v[52:53], v[54:55]
    v_exp_f32 v50, v48
    v_exp_f32 v51, v49
    v_exp_f32 v56, v54
    v_exp_f32 v57, v55
    v_pk_add_f32 v[50:51], v[50:51], v[44:45]
    v_pk_add_f32 v[56:57], v[56:57], v[44:45]
    v_rcp_f32 v50, v50
    v_rcp_f32 v51, v51
    v_rcp_f32 v56, v56
    v_rcp_f32 v57, v57
    v_pk_mul_f32 v[46:47], v[46:47], v[50:51]
    v_pk_mul_f32 v[52:53], v[52:53], v[56:57]
    v_cvt_pk_bf16_f32 v58, v46, v47
    v_cvt_pk_bf16_f32 v59, v52, v53
    v_pk_add_f32 v[46:47], v[132:133], v[20:21]
    v_pk_add_f32 v[52:53], v[134:135], v[22:23]
    v_pk_fma_f32 v[46:47], v[46:47], v[28:29], v[36:37]
    v_pk_fma_f32 v[52:53], v[52:53], v[30:31], v[38:39]
    v_pk_mul_f32 v[48:49], v[46:47], v[46:47]
    v_pk_mul_f32 v[54:55], v[52:53], v[52:53]
    v_pk_fma_f32 v[48:49], v[48:49], v[40:41], v[42:43]
    v_pk_fma_f32 v[54:55], v[54:55], v[40:41], v[42:43]
    v_pk_mul_f32 v[48:49], v[46:47], v[48:49]
    v_pk_mul_f32 v[54:55], v[52:53], v[54:55]
    v_exp_f32 v50, v48
    v_exp_f32 v51, v49
    v_exp_f32 v56, v54
    v_exp_f32 v57, v55
    v_pk_add_f32 v[50:51], v[50:51], v[44:45]
    v_pk_add_f32 v[56:57], v[56:57], v[44:45]
    v_rcp_f32 v50, v50
    v_rcp_f32 v51, v51
    v_rcp_f32 v56, v56
    v_rcp_f32 v57, v57
    v_pk_mul_f32 v[46:47], v[46:47], v[50:51]
    v_pk_mul_f32 v[52:53], v[52:53], v[56:57]
    v_cvt_pk_bf16_f32 v60, v46, v47
    v_cvt_pk_bf16_f32 v61, v52, v53
    v_cmp_gt_u32 vcc, 7998, v9
    v_add_u32 v2, 0, v8
    s_nop 0
    v_cndmask_b32 v2, v5, v2, vcc
    buffer_store_dwordx4 v[58:61], v2, s[16:19], 0 offen sc1
    v_pk_add_f32 v[46:47], v[136:137], v[16:17]
    v_pk_add_f32 v[52:53], v[138:139], v[18:19]
    v_pk_fma_f32 v[46:47], v[46:47], v[24:25], v[32:33]
    v_pk_fma_f32 v[52:53], v[52:53], v[26:27], v[34:35]
    v_pk_mul_f32 v[48:49], v[46:47], v[46:47]
    v_pk_mul_f32 v[54:55], v[52:53], v[52:53]
    v_pk_fma_f32 v[48:49], v[48:49], v[40:41], v[42:43]
    v_pk_fma_f32 v[54:55], v[54:55], v[40:41], v[42:43]
    v_pk_mul_f32 v[48:49], v[46:47], v[48:49]
    v_pk_mul_f32 v[54:55], v[52:53], v[54:55]
    v_exp_f32 v50, v48
    v_exp_f32 v51, v49
    v_exp_f32 v56, v54
    v_exp_f32 v57, v55
    v_pk_add_f32 v[50:51], v[50:51], v[44:45]
    v_pk_add_f32 v[56:57], v[56:57], v[44:45]
    v_rcp_f32 v50, v50
    v_rcp_f32 v51, v51
    v_rcp_f32 v56, v56
    v_rcp_f32 v57, v57
    v_pk_mul_f32 v[46:47], v[46:47], v[50:51]
    v_pk_mul_f32 v[52:53], v[52:53], v[56:57]
    v_cvt_pk_bf16_f32 v62, v46, v47
    v_cvt_pk_bf16_f32 v63, v52, v53
    v_pk_add_f32 v[46:47], v[140:141], v[20:21]
    v_pk_add_f32 v[52:53], v[142:143], v[22:23]
    v_pk_fma_f32 v[46:47], v[46:47], v[28:29], v[36:37]
    v_pk_fma_f32 v[52:53], v[52:53], v[30:31], v[38:39]
    v_pk_mul_f32 v[48:49], v[46:47], v[46:47]
    v_pk_mul_f32 v[54:55], v[52:53], v[52:53]
    v_pk_fma_f32 v[48:49], v[48:49], v[40:41], v[42:43]
    v_pk_fma_f32 v[54:55], v[54:55], v[40:41], v[42:43]
    v_pk_mul_f32 v[48:49], v[46:47], v[48:49]
    v_pk_mul_f32 v[54:55], v[52:53], v[54:55]
    v_exp_f32 v50, v48
    v_exp_f32 v51, v49
    v_exp_f32 v56, v54
    v_exp_f32 v57, v55
    v_pk_add_f32 v[50:51], v[50:51], v[44:45]
    v_pk_add_f32 v[56:57], v[56:57], v[44:45]
    v_rcp_f32 v50, v50
    v_rcp_f32 v51, v51
    v_rcp_f32 v56, v56
    v_rcp_f32 v57, v57
    v_pk_mul_f32 v[46:47], v[46:47], v[50:51]
    v_pk_mul_f32 v[52:53], v[52:53], v[56:57]
    v_cvt_pk_bf16_f32 v64, v46, v47
    v_cvt_pk_bf16_f32 v65, v52, v53
    v_cmp_gt_u32 vcc, 7990, v9
    v_add_u32 v2, 8192, v8
    s_nop 0
    v_cndmask_b32 v2, v5, v2, vcc
    buffer_store_dwordx4 v[62:65], v2, s[16:19], 0 offen sc1
    v_pk_add_f32 v[46:47], v[144:145], v[16:17]
    v_pk_add_f32 v[52:53], v[146:147], v[18:19]
    v_pk_fma_f32 v[46:47], v[46:47], v[24:25], v[32:33]
    v_pk_fma_f32 v[52:53], v[52:53], v[26:27], v[34:35]
    v_pk_mul_f32 v[48:49], v[46:47], v[46:47]
    v_pk_mul_f32 v[54:55], v[52:53], v[52:53]
    v_pk_fma_f32 v[48:49], v[48:49], v[40:41], v[42:43]
    v_pk_fma_f32 v[54:55], v[54:55], v[40:41], v[42:43]
    v_pk_mul_f32 v[48:49], v[46:47], v[48:49]
    v_pk_mul_f32 v[54:55], v[52:53], v[54:55]
    v_exp_f32 v50, v48
    v_exp_f32 v51, v49
    v_exp_f32 v56, v54
    v_exp_f32 v57, v55
    v_pk_add_f32 v[50:51], v[50:51], v[44:45]
    v_pk_add_f32 v[56:57], v[56:57], v[44:45]
    v_rcp_f32 v50, v50
    v_rcp_f32 v51, v51
    v_rcp_f32 v56, v56
    v_rcp_f32 v57, v57
    v_pk_mul_f32 v[46:47], v[46:47], v[50:51]
    v_pk_mul_f32 v[52:53], v[52:53], v[56:57]
    v_cvt_pk_bf16_f32 v66, v46, v47
    v_cvt_pk_bf16_f32 v67, v52, v53
    v_pk_add_f32 v[46:47], v[148:149], v[20:21]
    v_pk_add_f32 v[52:53], v[150:151], v[22:23]
    v_pk_fma_f32 v[46:47], v[46:47], v[28:29], v[36:37]
    v_pk_fma_f32 v[52:53], v[52:53], v[30:31], v[38:39]
    v_pk_mul_f32 v[48:49], v[46:47], v[46:47]
    v_pk_mul_f32 v[54:55], v[52:53], v[52:53]
    v_pk_fma_f32 v[48:49], v[48:49], v[40:41], v[42:43]
    v_pk_fma_f32 v[54:55], v[54:55], v[40:41], v[42:43]
    v_pk_mul_f32 v[48:49], v[46:47], v[48:49]
    v_pk_mul_f32 v[54:55], v[52:53], v[54:55]
    v_exp_f32 v50, v48
    v_exp_f32 v51, v49
    v_exp_f32 v56, v54
    v_exp_f32 v57, v55
    v_pk_add_f32 v[50:51], v[50:51], v[44:45]
    v_pk_add_f32 v[56:57], v[56:57], v[44:45]
    v_rcp_f32 v50, v50
    v_rcp_f32 v51, v51
    v_rcp_f32 v56, v56
    v_rcp_f32 v57, v57
    v_pk_mul_f32 v[46:47], v[46:47], v[50:51]
    v_pk_mul_f32 v[52:53], v[52:53], v[56:57]
    v_cvt_pk_bf16_f32 v68, v46, v47
    v_cvt_pk_bf16_f32 v69, v52, v53
    v_cmp_gt_u32 vcc, 7982, v9
    v_add_u32 v2, 16384, v8
    s_nop 0
    v_cndmask_b32 v2, v5, v2, vcc
    buffer_store_dwordx4 v[66:69], v2, s[16:19], 0 offen sc1
    v_pk_add_f32 v[46:47], v[152:153], v[16:17]
    v_pk_add_f32 v[52:53], v[154:155], v[18:19]
    v_pk_fma_f32 v[46:47], v[46:47], v[24:25], v[32:33]
    v_pk_fma_f32 v[52:53], v[52:53], v[26:27], v[34:35]
    v_pk_mul_f32 v[48:49], v[46:47], v[46:47]
    v_pk_mul_f32 v[54:55], v[52:53], v[52:53]
    v_pk_fma_f32 v[48:49], v[48:49], v[40:41], v[42:43]
    v_pk_fma_f32 v[54:55], v[54:55], v[40:41], v[42:43]
    v_pk_mul_f32 v[48:49], v[46:47], v[48:49]
    v_pk_mul_f32 v[54:55], v[52:53], v[54:55]
    v_exp_f32 v50, v48
    v_exp_f32 v51, v49
    v_exp_f32 v56, v54
    v_exp_f32 v57, v55
    v_pk_add_f32 v[50:51], v[50:51], v[44:45]
    v_pk_add_f32 v[56:57], v[56:57], v[44:45]
    v_rcp_f32 v50, v50
    v_rcp_f32 v51, v51
    v_rcp_f32 v56, v56
    v_rcp_f32 v57, v57
    v_pk_mul_f32 v[46:47], v[46:47], v[50:51]
    v_pk_mul_f32 v[52:53], v[52:53], v[56:57]
    v_cvt_pk_bf16_f32 v70, v46, v47
    v_cvt_pk_bf16_f32 v71, v52, v53
    v_pk_add_f32 v[46:47], v[156:157], v[20:21]
    v_pk_add_f32 v[52:53], v[158:159], v[22:23]
    v_pk_fma_f32 v[46:47], v[46:47], v[28:29], v[36:37]
    v_pk_fma_f32 v[52:53], v[52:53], v[30:31], v[38:39]
    v_pk_mul_f32 v[48:49], v[46:47], v[46:47]
    v_pk_mul_f32 v[54:55], v[52:53], v[52:53]
    v_pk_fma_f32 v[48:49], v[48:49], v[40:41], v[42:43]
    v_pk_fma_f32 v[54:55], v[54:55], v[40:41], v[42:43]
    v_pk_mul_f32 v[48:49], v[46:47], v[48:49]
    v_pk_mul_f32 v[54:55], v[52:53], v[54:55]
    v_exp_f32 v50, v48
    v_exp_f32 v51, v49
    v_exp_f32 v56, v54
    v_exp_f32 v57, v55
    v_pk_add_f32 v[50:51], v[50:51], v[44:45]
    v_pk_add_f32 v[56:57], v[56:57], v[44:45]
    v_rcp_f32 v50, v50
    v_rcp_f32 v51, v51
    v_rcp_f32 v56, v56
    v_rcp_f32 v57, v57
    v_pk_mul_f32 v[46:47], v[46:47], v[50:51]
    v_pk_mul_f32 v[52:53], v[52:53], v[56:57]
    v_cvt_pk_bf16_f32 v72, v46, v47
    v_cvt_pk_bf16_f32 v73, v52, v53
    v_cmp_gt_u32 vcc, 7974, v9
    v_add_u32 v2, 24576, v8
    s_nop 0
    v_cndmask_b32 v2, v5, v2, vcc
    buffer_store_dwordx4 v[70:73], v2, s[16:19], 0 offen sc1
    v_pk_add_f32 v[46:47], v[160:161], v[16:17]
    v_pk_add_f32 v[52:53], v[162:163], v[18:19]
    v_pk_fma_f32 v[46:47], v[46:47], v[24:25], v[32:33]
    v_pk_fma_f32 v[52:53], v[52:53], v[26:27], v[34:35]
    v_pk_mul_f32 v[48:49], v[46:47], v[46:47]
    v_pk_mul_f32 v[54:55], v[52:53], v[52:53]
    v_pk_fma_f32 v[48:49], v[48:49], v[40:41], v[42:43]
    v_pk_fma_f32 v[54:55], v[54:55], v[40:41], v[42:43]
    v_pk_mul_f32 v[48:49], v[46:47], v[48:49]
    v_pk_mul_f32 v[54:55], v[52:53], v[54:55]
    v_exp_f32 v50, v48
    v_exp_f32 v51, v49
    v_exp_f32 v56, v54
    v_exp_f32 v57, v55
    v_pk_add_f32 v[50:51], v[50:51], v[44:45]
    v_pk_add_f32 v[56:57], v[56:57], v[44:45]
    v_rcp_f32 v50, v50
    v_rcp_f32 v51, v51
    v_rcp_f32 v56, v56
    v_rcp_f32 v57, v57
    v_pk_mul_f32 v[46:47], v[46:47], v[50:51]
    v_pk_mul_f32 v[52:53], v[52:53], v[56:57]
    v_cvt_pk_bf16_f32 v58, v46, v47
    v_cvt_pk_bf16_f32 v59, v52, v53
    v_pk_add_f32 v[46:47], v[164:165], v[20:21]
    v_pk_add_f32 v[52:53], v[166:167], v[22:23]
    v_pk_fma_f32 v[46:47], v[46:47], v[28:29], v[36:37]
    v_pk_fma_f32 v[52:53], v[52:53], v[30:31], v[38:39]
    v_pk_mul_f32 v[48:49], v[46:47], v[46:47]
    v_pk_mul_f32 v[54:55], v[52:53], v[52:53]
    v_pk_fma_f32 v[48:49], v[48:49], v[40:41], v[42:43]
    v_pk_fma_f32 v[54:55], v[54:55], v[40:41], v[42:43]
    v_pk_mul_f32 v[48:49], v[46:47], v[48:49]
    v_pk_mul_f32 v[54:55], v[52:53], v[54:55]
    v_exp_f32 v50, v48
    v_exp_f32 v51, v49
    v_exp_f32 v56, v54
    v_exp_f32 v57, v55
    v_pk_add_f32 v[50:51], v[50:51], v[44:45]
    v_pk_add_f32 v[56:57], v[56:57], v[44:45]
    v_rcp_f32 v50, v50
    v_rcp_f32 v51, v51
    v_rcp_f32 v56, v56
    v_rcp_f32 v57, v57
    v_pk_mul_f32 v[46:47], v[46:47], v[50:51]
    v_pk_mul_f32 v[52:53], v[52:53], v[56:57]
    v_cvt_pk_bf16_f32 v60, v46, v47
    v_cvt_pk_bf16_f32 v61, v52, v53
    v_cmp_gt_u32 vcc, 7966, v9
    v_add_u32 v2, 32768, v8
    s_nop 0
    v_cndmask_b32 v2, v5, v2, vcc
    buffer_store_dwordx4 v[58:61], v2, s[16:19], 0 offen sc1
    v_pk_add_f32 v[46:47], v[168:169], v[16:17]
    v_pk_add_f32 v[52:53], v[170:171], v[18:19]
    v_pk_fma_f32 v[46:47], v[46:47], v[24:25], v[32:33]
    v_pk_fma_f32 v[52:53], v[52:53], v[26:27], v[34:35]
    v_pk_mul_f32 v[48:49], v[46:47], v[46:47]
    v_pk_mul_f32 v[54:55], v[52:53], v[52:53]
    v_pk_fma_f32 v[48:49], v[48:49], v[40:41], v[42:43]
    v_pk_fma_f32 v[54:55], v[54:55], v[40:41], v[42:43]
    v_pk_mul_f32 v[48:49], v[46:47], v[48:49]
    v_pk_mul_f32 v[54:55], v[52:53], v[54:55]
    v_exp_f32 v50, v48
    v_exp_f32 v51, v49
    v_exp_f32 v56, v54
    v_exp_f32 v57, v55
    v_pk_add_f32 v[50:51], v[50:51], v[44:45]
    v_pk_add_f32 v[56:57], v[56:57], v[44:45]
    v_rcp_f32 v50, v50
    v_rcp_f32 v51, v51
    v_rcp_f32 v56, v56
    v_rcp_f32 v57, v57
    v_pk_mul_f32 v[46:47], v[46:47], v[50:51]
    v_pk_mul_f32 v[52:53], v[52:53], v[56:57]
    v_cvt_pk_bf16_f32 v62, v46, v47
    v_cvt_pk_bf16_f32 v63, v52, v53
    v_pk_add_f32 v[46:47], v[172:173], v[20:21]
    v_pk_add_f32 v[52:53], v[174:175], v[22:23]
    v_pk_fma_f32 v[46:47], v[46:47], v[28:29], v[36:37]
    v_pk_fma_f32 v[52:53], v[52:53], v[30:31], v[38:39]
    v_pk_mul_f32 v[48:49], v[46:47], v[46:47]
    v_pk_mul_f32 v[54:55], v[52:53], v[52:53]
    v_pk_fma_f32 v[48:49], v[48:49], v[40:41], v[42:43]
    v_pk_fma_f32 v[54:55], v[54:55], v[40:41], v[42:43]
    v_pk_mul_f32 v[48:49], v[46:47], v[48:49]
    v_pk_mul_f32 v[54:55], v[52:53], v[54:55]
    v_exp_f32 v50, v48
    v_exp_f32 v51, v49
    v_exp_f32 v56, v54
    v_exp_f32 v57, v55
    v_pk_add_f32 v[50:51], v[50:51], v[44:45]
    v_pk_add_f32 v[56:57], v[56:57], v[44:45]
    v_rcp_f32 v50, v50
    v_rcp_f32 v51, v51
    v_rcp_f32 v56, v56
    v_rcp_f32 v57, v57
    v_pk_mul_f32 v[46:47], v[46:47], v[50:51]
    v_pk_mul_f32 v[52:53], v[52:53], v[56:57]
    v_cvt_pk_bf16_f32 v64, v46, v47
    v_cvt_pk_bf16_f32 v65, v52, v53
    v_cmp_gt_u32 vcc, 7958, v9
    v_add_u32 v2, 40960, v8
    s_nop 0
    v_cndmask_b32 v2, v5, v2, vcc
    buffer_store_dwordx4 v[62:65], v2, s[16:19], 0 offen sc1
    v_pk_add_f32 v[46:47], v[176:177], v[16:17]
    v_pk_add_f32 v[52:53], v[178:179], v[18:19]
    v_pk_fma_f32 v[46:47], v[46:47], v[24:25], v[32:33]
    v_pk_fma_f32 v[52:53], v[52:53], v[26:27], v[34:35]
    v_pk_mul_f32 v[48:49], v[46:47], v[46:47]
    v_pk_mul_f32 v[54:55], v[52:53], v[52:53]
    v_pk_fma_f32 v[48:49], v[48:49], v[40:41], v[42:43]
    v_pk_fma_f32 v[54:55], v[54:55], v[40:41], v[42:43]
    v_pk_mul_f32 v[48:49], v[46:47], v[48:49]
    v_pk_mul_f32 v[54:55], v[52:53], v[54:55]
    v_exp_f32 v50, v48
    v_exp_f32 v51, v49
    v_exp_f32 v56, v54
    v_exp_f32 v57, v55
    v_pk_add_f32 v[50:51], v[50:51], v[44:45]
    v_pk_add_f32 v[56:57], v[56:57], v[44:45]
    v_rcp_f32 v50, v50
    v_rcp_f32 v51, v51
    v_rcp_f32 v56, v56
    v_rcp_f32 v57, v57
    v_pk_mul_f32 v[46:47], v[46:47], v[50:51]
    v_pk_mul_f32 v[52:53], v[52:53], v[56:57]
    v_cvt_pk_bf16_f32 v66, v46, v47
    v_cvt_pk_bf16_f32 v67, v52, v53
    v_pk_add_f32 v[46:47], v[180:181], v[20:21]
    v_pk_add_f32 v[52:53], v[182:183], v[22:23]
    v_pk_fma_f32 v[46:47], v[46:47], v[28:29], v[36:37]
    v_pk_fma_f32 v[52:53], v[52:53], v[30:31], v[38:39]
    v_pk_mul_f32 v[48:49], v[46:47], v[46:47]
    v_pk_mul_f32 v[54:55], v[52:53], v[52:53]
    v_pk_fma_f32 v[48:49], v[48:49], v[40:41], v[42:43]
    v_pk_fma_f32 v[54:55], v[54:55], v[40:41], v[42:43]
    v_pk_mul_f32 v[48:49], v[46:47], v[48:49]
    v_pk_mul_f32 v[54:55], v[52:53], v[54:55]
    v_exp_f32 v50, v48
    v_exp_f32 v51, v49
    v_exp_f32 v56, v54
    v_exp_f32 v57, v55
    v_pk_add_f32 v[50:51], v[50:51], v[44:45]
    v_pk_add_f32 v[56:57], v[56:57], v[44:45]
    v_rcp_f32 v50, v50
    v_rcp_f32 v51, v51
    v_rcp_f32 v56, v56
    v_rcp_f32 v57, v57
    v_pk_mul_f32 v[46:47], v[46:47], v[50:51]
    v_pk_mul_f32 v[52:53], v[52:53], v[56:57]
    v_cvt_pk_bf16_f32 v68, v46, v47
    v_cvt_pk_bf16_f32 v69, v52, v53
    v_cmp_gt_u32 vcc, 7950, v9
    v_add_u32 v2, 49152, v8
    s_nop 0
    v_cndmask_b32 v2, v5, v2, vcc
    buffer_store_dwordx4 v[66:69], v2, s[16:19], 0 offen sc1
    v_pk_add_f32 v[46:47], v[184:185], v[16:17]
    v_pk_add_f32 v[52:53], v[186:187], v[18:19]
    v_pk_fma_f32 v[46:47], v[46:47], v[24:25], v[32:33]
    v_pk_fma_f32 v[52:53], v[52:53], v[26:27], v[34:35]
    v_pk_mul_f32 v[48:49], v[46:47], v[46:47]
    v_pk_mul_f32 v[54:55], v[52:53], v[52:53]
    v_pk_fma_f32 v[48:49], v[48:49], v[40:41], v[42:43]
    v_pk_fma_f32 v[54:55], v[54:55], v[40:41], v[42:43]
    v_pk_mul_f32 v[48:49], v[46:47], v[48:49]
    v_pk_mul_f32 v[54:55], v[52:53], v[54:55]
    v_exp_f32 v50, v48
    v_exp_f32 v51, v49
    v_exp_f32 v56, v54
    v_exp_f32 v57, v55
    v_pk_add_f32 v[50:51], v[50:51], v[44:45]
    v_pk_add_f32 v[56:57], v[56:57], v[44:45]
    v_rcp_f32 v50, v50
    v_rcp_f32 v51, v51
    v_rcp_f32 v56, v56
    v_rcp_f32 v57, v57
    v_pk_mul_f32 v[46:47], v[46:47], v[50:51]
    v_pk_mul_f32 v[52:53], v[52:53], v[56:57]
    v_cvt_pk_bf16_f32 v70, v46, v47
    v_cvt_pk_bf16_f32 v71, v52, v53
    v_pk_add_f32 v[46:47], v[188:189], v[20:21]
    v_pk_add_f32 v[52:53], v[190:191], v[22:23]
    v_pk_fma_f32 v[46:47], v[46:47], v[28:29], v[36:37]
    v_pk_fma_f32 v[52:53], v[52:53], v[30:31], v[38:39]
    v_pk_mul_f32 v[48:49], v[46:47], v[46:47]
    v_pk_mul_f32 v[54:55], v[52:53], v[52:53]
    v_pk_fma_f32 v[48:49], v[48:49], v[40:41], v[42:43]
    v_pk_fma_f32 v[54:55], v[54:55], v[40:41], v[42:43]
    v_pk_mul_f32 v[48:49], v[46:47], v[48:49]
    v_pk_mul_f32 v[54:55], v[52:53], v[54:55]
    v_exp_f32 v50, v48
    v_exp_f32 v51, v49
    v_exp_f32 v56, v54
    v_exp_f32 v57, v55
    v_pk_add_f32 v[50:51], v[50:51], v[44:45]
    v_pk_add_f32 v[56:57], v[56:57], v[44:45]
    v_rcp_f32 v50, v50
    v_rcp_f32 v51, v51
    v_rcp_f32 v56, v56
    v_rcp_f32 v57, v57
    v_pk_mul_f32 v[46:47], v[46:47], v[50:51]
    v_pk_mul_f32 v[52:53], v[52:53], v[56:57]
    v_cvt_pk_bf16_f32 v72, v46, v47
    v_cvt_pk_bf16_f32 v73, v52, v53
    v_cmp_gt_u32 vcc, 7942, v9
    v_add_u32 v2, 57344, v8
    s_nop 0
    v_cndmask_b32 v2, v5, v2, vcc
    buffer_store_dwordx4 v[70:73], v2, s[16:19], 0 offen sc1
    v_pk_add_f32 v[46:47], v[192:193], v[16:17]
    v_pk_add_f32 v[52:53], v[194:195], v[18:19]
    v_pk_fma_f32 v[46:47], v[46:47], v[24:25], v[32:33]
    v_pk_fma_f32 v[52:53], v[52:53], v[26:27], v[34:35]
    v_pk_mul_f32 v[48:49], v[46:47], v[46:47]
    v_pk_mul_f32 v[54:55], v[52:53], v[52:53]
    v_pk_fma_f32 v[48:49], v[48:49], v[40:41], v[42:43]
    v_pk_fma_f32 v[54:55], v[54:55], v[40:41], v[42:43]
    v_pk_mul_f32 v[48:49], v[46:47], v[48:49]
    v_pk_mul_f32 v[54:55], v[52:53], v[54:55]
    v_exp_f32 v50, v48
    v_exp_f32 v51, v49
    v_exp_f32 v56, v54
    v_exp_f32 v57, v55
    v_pk_add_f32 v[50:51], v[50:51], v[44:45]
    v_pk_add_f32 v[56:57], v[56:57], v[44:45]
    v_rcp_f32 v50, v50
    v_rcp_f32 v51, v51
    v_rcp_f32 v56, v56
    v_rcp_f32 v57, v57
    v_pk_mul_f32 v[46:47], v[46:47], v[50:51]
    v_pk_mul_f32 v[52:53], v[52:53], v[56:57]
    v_cvt_pk_bf16_f32 v58, v46, v47
    v_cvt_pk_bf16_f32 v59, v52, v53
    v_pk_add_f32 v[46:47], v[196:197], v[20:21]
    v_pk_add_f32 v[52:53], v[198:199], v[22:23]
    v_pk_fma_f32 v[46:47], v[46:47], v[28:29], v[36:37]
    v_pk_fma_f32 v[52:53], v[52:53], v[30:31], v[38:39]
    v_pk_mul_f32 v[48:49], v[46:47], v[46:47]
    v_pk_mul_f32 v[54:55], v[52:53], v[52:53]
    v_pk_fma_f32 v[48:49], v[48:49], v[40:41], v[42:43]
    v_pk_fma_f32 v[54:55], v[54:55], v[40:41], v[42:43]
    v_pk_mul_f32 v[48:49], v[46:47], v[48:49]
    v_pk_mul_f32 v[54:55], v[52:53], v[54:55]
    v_exp_f32 v50, v48
    v_exp_f32 v51, v49
    v_exp_f32 v56, v54
    v_exp_f32 v57, v55
    v_pk_add_f32 v[50:51], v[50:51], v[44:45]
    v_pk_add_f32 v[56:57], v[56:57], v[44:45]
    v_rcp_f32 v50, v50
    v_rcp_f32 v51, v51
    v_rcp_f32 v56, v56
    v_rcp_f32 v57, v57
    v_pk_mul_f32 v[46:47], v[46:47], v[50:51]
    v_pk_mul_f32 v[52:53], v[52:53], v[56:57]
    v_cvt_pk_bf16_f32 v60, v46, v47
    v_cvt_pk_bf16_f32 v61, v52, v53
    v_cmp_gt_u32 vcc, 7934, v9
    v_add_u32 v2, 65536, v8
    s_nop 0
    v_cndmask_b32 v2, v5, v2, vcc
    buffer_store_dwordx4 v[58:61], v2, s[16:19], 0 offen sc1
    v_pk_add_f32 v[46:47], v[200:201], v[16:17]
    v_pk_add_f32 v[52:53], v[202:203], v[18:19]
    v_pk_fma_f32 v[46:47], v[46:47], v[24:25], v[32:33]
    v_pk_fma_f32 v[52:53], v[52:53], v[26:27], v[34:35]
    v_pk_mul_f32 v[48:49], v[46:47], v[46:47]
    v_pk_mul_f32 v[54:55], v[52:53], v[52:53]
    v_pk_fma_f32 v[48:49], v[48:49], v[40:41], v[42:43]
    v_pk_fma_f32 v[54:55], v[54:55], v[40:41], v[42:43]
    v_pk_mul_f32 v[48:49], v[46:47], v[48:49]
    v_pk_mul_f32 v[54:55], v[52:53], v[54:55]
    v_exp_f32 v50, v48
    v_exp_f32 v51, v49
    v_exp_f32 v56, v54
    v_exp_f32 v57, v55
    v_pk_add_f32 v[50:51], v[50:51], v[44:45]
    v_pk_add_f32 v[56:57], v[56:57], v[44:45]
    v_rcp_f32 v50, v50
    v_rcp_f32 v51, v51
    v_rcp_f32 v56, v56
    v_rcp_f32 v57, v57
    v_pk_mul_f32 v[46:47], v[46:47], v[50:51]
    v_pk_mul_f32 v[52:53], v[52:53], v[56:57]
    v_cvt_pk_bf16_f32 v62, v46, v47
    v_cvt_pk_bf16_f32 v63, v52, v53
    v_pk_add_f32 v[46:47], v[204:205], v[20:21]
    v_pk_add_f32 v[52:53], v[206:207], v[22:23]
    v_pk_fma_f32 v[46:47], v[46:47], v[28:29], v[36:37]
    v_pk_fma_f32 v[52:53], v[52:53], v[30:31], v[38:39]
    v_pk_mul_f32 v[48:49], v[46:47], v[46:47]
    v_pk_mul_f32 v[54:55], v[52:53], v[52:53]
    v_pk_fma_f32 v[48:49], v[48:49], v[40:41], v[42:43]
    v_pk_fma_f32 v[54:55], v[54:55], v[40:41], v[42:43]
    v_pk_mul_f32 v[48:49], v[46:47], v[48:49]
    v_pk_mul_f32 v[54:55], v[52:53], v[54:55]
    v_exp_f32 v50, v48
    v_exp_f32 v51, v49
    v_exp_f32 v56, v54
    v_exp_f32 v57, v55
    v_pk_add_f32 v[50:51], v[50:51], v[44:45]
    v_pk_add_f32 v[56:57], v[56:57], v[44:45]
    v_rcp_f32 v50, v50
    v_rcp_f32 v51, v51
    v_rcp_f32 v56, v56
    v_rcp_f32 v57, v57
    v_pk_mul_f32 v[46:47], v[46:47], v[50:51]
    v_pk_mul_f32 v[52:53], v[52:53], v[56:57]
    v_cvt_pk_bf16_f32 v64, v46, v47
    v_cvt_pk_bf16_f32 v65, v52, v53
    v_cmp_gt_u32 vcc, 7926, v9
    v_add_u32 v2, 73728, v8
    s_nop 0
    v_cndmask_b32 v2, v5, v2, vcc
    buffer_store_dwordx4 v[62:65], v2, s[16:19], 0 offen sc1
    v_pk_add_f32 v[46:47], v[208:209], v[16:17]
    v_pk_add_f32 v[52:53], v[210:211], v[18:19]
    v_pk_fma_f32 v[46:47], v[46:47], v[24:25], v[32:33]
    v_pk_fma_f32 v[52:53], v[52:53], v[26:27], v[34:35]
    v_pk_mul_f32 v[48:49], v[46:47], v[46:47]
    v_pk_mul_f32 v[54:55], v[52:53], v[52:53]
    v_pk_fma_f32 v[48:49], v[48:49], v[40:41], v[42:43]
    v_pk_fma_f32 v[54:55], v[54:55], v[40:41], v[42:43]
    v_pk_mul_f32 v[48:49], v[46:47], v[48:49]
    v_pk_mul_f32 v[54:55], v[52:53], v[54:55]
    v_exp_f32 v50, v48
    v_exp_f32 v51, v49
    v_exp_f32 v56, v54
    v_exp_f32 v57, v55
    v_pk_add_f32 v[50:51], v[50:51], v[44:45]
    v_pk_add_f32 v[56:57], v[56:57], v[44:45]
    v_rcp_f32 v50, v50
    v_rcp_f32 v51, v51
    v_rcp_f32 v56, v56
    v_rcp_f32 v57, v57
    v_pk_mul_f32 v[46:47], v[46:47], v[50:51]
    v_pk_mul_f32 v[52:53], v[52:53], v[56:57]
    v_cvt_pk_bf16_f32 v66, v46, v47
    v_cvt_pk_bf16_f32 v67, v52, v53
    v_pk_add_f32 v[46:47], v[212:213], v[20:21]
    v_pk_add_f32 v[52:53], v[214:215], v[22:23]
    v_pk_fma_f32 v[46:47], v[46:47], v[28:29], v[36:37]
    v_pk_fma_f32 v[52:53], v[52:53], v[30:31], v[38:39]
    v_pk_mul_f32 v[48:49], v[46:47], v[46:47]
    v_pk_mul_f32 v[54:55], v[52:53], v[52:53]
    v_pk_fma_f32 v[48:49], v[48:49], v[40:41], v[42:43]
    v_pk_fma_f32 v[54:55], v[54:55], v[40:41], v[42:43]
    v_pk_mul_f32 v[48:49], v[46:47], v[48:49]
    v_pk_mul_f32 v[54:55], v[52:53], v[54:55]
    v_exp_f32 v50, v48
    v_exp_f32 v51, v49
    v_exp_f32 v56, v54
    v_exp_f32 v57, v55
    v_pk_add_f32 v[50:51], v[50:51], v[44:45]
    v_pk_add_f32 v[56:57], v[56:57], v[44:45]
    v_rcp_f32 v50, v50
    v_rcp_f32 v51, v51
    v_rcp_f32 v56, v56
    v_rcp_f32 v57, v57
    v_pk_mul_f32 v[46:47], v[46:47], v[50:51]
    v_pk_mul_f32 v[52:53], v[52:53], v[56:57]
    v_cvt_pk_bf16_f32 v68, v46, v47
    v_cvt_pk_bf16_f32 v69, v52, v53
    v_cmp_gt_u32 vcc, 7918, v9
    v_add_u32 v2, 81920, v8
    s_nop 0
    v_cndmask_b32 v2, v5, v2, vcc
    buffer_store_dwordx4 v[66:69], v2, s[16:19], 0 offen sc1
    v_pk_add_f32 v[46:47], v[216:217], v[16:17]
    v_pk_add_f32 v[52:53], v[218:219], v[18:19]
    v_pk_fma_f32 v[46:47], v[46:47], v[24:25], v[32:33]
    v_pk_fma_f32 v[52:53], v[52:53], v[26:27], v[34:35]
    v_pk_mul_f32 v[48:49], v[46:47], v[46:47]
    v_pk_mul_f32 v[54:55], v[52:53], v[52:53]
    v_pk_fma_f32 v[48:49], v[48:49], v[40:41], v[42:43]
    v_pk_fma_f32 v[54:55], v[54:55], v[40:41], v[42:43]
    v_pk_mul_f32 v[48:49], v[46:47], v[48:49]
    v_pk_mul_f32 v[54:55], v[52:53], v[54:55]
    v_exp_f32 v50, v48
    v_exp_f32 v51, v49
    v_exp_f32 v56, v54
    v_exp_f32 v57, v55
    v_pk_add_f32 v[50:51], v[50:51], v[44:45]
    v_pk_add_f32 v[56:57], v[56:57], v[44:45]
    v_rcp_f32 v50, v50
    v_rcp_f32 v51, v51
    v_rcp_f32 v56, v56
    v_rcp_f32 v57, v57
    v_pk_mul_f32 v[46:47], v[46:47], v[50:51]
    v_pk_mul_f32 v[52:53], v[52:53], v[56:57]
    v_cvt_pk_bf16_f32 v70, v46, v47
    v_cvt_pk_bf16_f32 v71, v52, v53
    v_pk_add_f32 v[46:47], v[220:221], v[20:21]
    v_pk_add_f32 v[52:53], v[222:223], v[22:23]
    v_pk_fma_f32 v[46:47], v[46:47], v[28:29], v[36:37]
    v_pk_fma_f32 v[52:53], v[52:53], v[30:31], v[38:39]
    v_pk_mul_f32 v[48:49], v[46:47], v[46:47]
    v_pk_mul_f32 v[54:55], v[52:53], v[52:53]
    v_pk_fma_f32 v[48:49], v[48:49], v[40:41], v[42:43]
    v_pk_fma_f32 v[54:55], v[54:55], v[40:41], v[42:43]
    v_pk_mul_f32 v[48:49], v[46:47], v[48:49]
    v_pk_mul_f32 v[54:55], v[52:53], v[54:55]
    v_exp_f32 v50, v48
    v_exp_f32 v51, v49
    v_exp_f32 v56, v54
    v_exp_f32 v57, v55
    v_pk_add_f32 v[50:51], v[50:51], v[44:45]
    v_pk_add_f32 v[56:57], v[56:57], v[44:45]
    v_rcp_f32 v50, v50
    v_rcp_f32 v51, v51
    v_rcp_f32 v56, v56
    v_rcp_f32 v57, v57
    v_pk_mul_f32 v[46:47], v[46:47], v[50:51]
    v_pk_mul_f32 v[52:53], v[52:53], v[56:57]
    v_cvt_pk_bf16_f32 v72, v46, v47
    v_cvt_pk_bf16_f32 v73, v52, v53
    v_cmp_gt_u32 vcc, 7910, v9
    v_add_u32 v2, 90112, v8
    s_nop 0
    v_cndmask_b32 v2, v5, v2, vcc
    buffer_store_dwordx4 v[70:73], v2, s[16:19], 0 offen sc1
    v_pk_add_f32 v[46:47], v[224:225], v[16:17]
    v_pk_add_f32 v[52:53], v[226:227], v[18:19]
    v_pk_fma_f32 v[46:47], v[46:47], v[24:25], v[32:33]
    v_pk_fma_f32 v[52:53], v[52:53], v[26:27], v[34:35]
    v_pk_mul_f32 v[48:49], v[46:47], v[46:47]
    v_pk_mul_f32 v[54:55], v[52:53], v[52:53]
    v_pk_fma_f32 v[48:49], v[48:49], v[40:41], v[42:43]
    v_pk_fma_f32 v[54:55], v[54:55], v[40:41], v[42:43]
    v_pk_mul_f32 v[48:49], v[46:47], v[48:49]
    v_pk_mul_f32 v[54:55], v[52:53], v[54:55]
    v_exp_f32 v50, v48
    v_exp_f32 v51, v49
    v_exp_f32 v56, v54
    v_exp_f32 v57, v55
    v_pk_add_f32 v[50:51], v[50:51], v[44:45]
    v_pk_add_f32 v[56:57], v[56:57], v[44:45]
    v_rcp_f32 v50, v50
    v_rcp_f32 v51, v51
    v_rcp_f32 v56, v56
    v_rcp_f32 v57, v57
    v_pk_mul_f32 v[46:47], v[46:47], v[50:51]
    v_pk_mul_f32 v[52:53], v[52:53], v[56:57]
    v_cvt_pk_bf16_f32 v58, v46, v47
    v_cvt_pk_bf16_f32 v59, v52, v53
    v_pk_add_f32 v[46:47], v[228:229], v[20:21]
    v_pk_add_f32 v[52:53], v[230:231], v[22:23]
    v_pk_fma_f32 v[46:47], v[46:47], v[28:29], v[36:37]
    v_pk_fma_f32 v[52:53], v[52:53], v[30:31], v[38:39]
    v_pk_mul_f32 v[48:49], v[46:47], v[46:47]
    v_pk_mul_f32 v[54:55], v[52:53], v[52:53]
    v_pk_fma_f32 v[48:49], v[48:49], v[40:41], v[42:43]
    v_pk_fma_f32 v[54:55], v[54:55], v[40:41], v[42:43]
    v_pk_mul_f32 v[48:49], v[46:47], v[48:49]
    v_pk_mul_f32 v[54:55], v[52:53], v[54:55]
    v_exp_f32 v50, v48
    v_exp_f32 v51, v49
    v_exp_f32 v56, v54
    v_exp_f32 v57, v55
    v_pk_add_f32 v[50:51], v[50:51], v[44:45]
    v_pk_add_f32 v[56:57], v[56:57], v[44:45]
    v_rcp_f32 v50, v50
    v_rcp_f32 v51, v51
    v_rcp_f32 v56, v56
    v_rcp_f32 v57, v57
    v_pk_mul_f32 v[46:47], v[46:47], v[50:51]
    v_pk_mul_f32 v[52:53], v[52:53], v[56:57]
    v_cvt_pk_bf16_f32 v60, v46, v47
    v_cvt_pk_bf16_f32 v61, v52, v53
    v_cmp_gt_u32 vcc, 7902, v9
    v_add_u32 v2, 98304, v8
    s_nop 0
    v_cndmask_b32 v2, v5, v2, vcc
    buffer_store_dwordx4 v[58:61], v2, s[16:19], 0 offen sc1
    v_pk_add_f32 v[46:47], v[232:233], v[16:17]
    v_pk_add_f32 v[52:53], v[234:235], v[18:19]
    v_pk_fma_f32 v[46:47], v[46:47], v[24:25], v[32:33]
    v_pk_fma_f32 v[52:53], v[52:53], v[26:27], v[34:35]
    v_pk_mul_f32 v[48:49], v[46:47], v[46:47]
    v_pk_mul_f32 v[54:55], v[52:53], v[52:53]
    v_pk_fma_f32 v[48:49], v[48:49], v[40:41], v[42:43]
    v_pk_fma_f32 v[54:55], v[54:55], v[40:41], v[42:43]
    v_pk_mul_f32 v[48:49], v[46:47], v[48:49]
    v_pk_mul_f32 v[54:55], v[52:53], v[54:55]
    v_exp_f32 v50, v48
    v_exp_f32 v51, v49
    v_exp_f32 v56, v54
    v_exp_f32 v57, v55
    v_pk_add_f32 v[50:51], v[50:51], v[44:45]
    v_pk_add_f32 v[56:57], v[56:57], v[44:45]
    v_rcp_f32 v50, v50
    v_rcp_f32 v51, v51
    v_rcp_f32 v56, v56
    v_rcp_f32 v57, v57
    v_pk_mul_f32 v[46:47], v[46:47], v[50:51]
    v_pk_mul_f32 v[52:53], v[52:53], v[56:57]
    v_cvt_pk_bf16_f32 v62, v46, v47
    v_cvt_pk_bf16_f32 v63, v52, v53
    v_pk_add_f32 v[46:47], v[236:237], v[20:21]
    v_pk_add_f32 v[52:53], v[238:239], v[22:23]
    v_pk_fma_f32 v[46:47], v[46:47], v[28:29], v[36:37]
    v_pk_fma_f32 v[52:53], v[52:53], v[30:31], v[38:39]
    v_pk_mul_f32 v[48:49], v[46:47], v[46:47]
    v_pk_mul_f32 v[54:55], v[52:53], v[52:53]
    v_pk_fma_f32 v[48:49], v[48:49], v[40:41], v[42:43]
    v_pk_fma_f32 v[54:55], v[54:55], v[40:41], v[42:43]
    v_pk_mul_f32 v[48:49], v[46:47], v[48:49]
    v_pk_mul_f32 v[54:55], v[52:53], v[54:55]
    v_exp_f32 v50, v48
    v_exp_f32 v51, v49
    v_exp_f32 v56, v54
    v_exp_f32 v57, v55
    v_pk_add_f32 v[50:51], v[50:51], v[44:45]
    v_pk_add_f32 v[56:57], v[56:57], v[44:45]
    v_rcp_f32 v50, v50
    v_rcp_f32 v51, v51
    v_rcp_f32 v56, v56
    v_rcp_f32 v57, v57
    v_pk_mul_f32 v[46:47], v[46:47], v[50:51]
    v_pk_mul_f32 v[52:53], v[52:53], v[56:57]
    v_cvt_pk_bf16_f32 v64, v46, v47
    v_cvt_pk_bf16_f32 v65, v52, v53
    v_cmp_gt_u32 vcc, 7894, v9
    v_add_u32 v2, 106496, v8
    s_nop 0
    v_cndmask_b32 v2, v5, v2, vcc
    buffer_store_dwordx4 v[62:65], v2, s[16:19], 0 offen sc1
    v_pk_add_f32 v[46:47], v[240:241], v[16:17]
    v_pk_add_f32 v[52:53], v[242:243], v[18:19]
    v_pk_fma_f32 v[46:47], v[46:47], v[24:25], v[32:33]
    v_pk_fma_f32 v[52:53], v[52:53], v[26:27], v[34:35]
    v_pk_mul_f32 v[48:49], v[46:47], v[46:47]
    v_pk_mul_f32 v[54:55], v[52:53], v[52:53]
    v_pk_fma_f32 v[48:49], v[48:49], v[40:41], v[42:43]
    v_pk_fma_f32 v[54:55], v[54:55], v[40:41], v[42:43]
    v_pk_mul_f32 v[48:49], v[46:47], v[48:49]
    v_pk_mul_f32 v[54:55], v[52:53], v[54:55]
    v_exp_f32 v50, v48
    v_exp_f32 v51, v49
    v_exp_f32 v56, v54
    v_exp_f32 v57, v55
    v_pk_add_f32 v[50:51], v[50:51], v[44:45]
    v_pk_add_f32 v[56:57], v[56:57], v[44:45]
    v_rcp_f32 v50, v50
    v_rcp_f32 v51, v51
    v_rcp_f32 v56, v56
    v_rcp_f32 v57, v57
    v_pk_mul_f32 v[46:47], v[46:47], v[50:51]
    v_pk_mul_f32 v[52:53], v[52:53], v[56:57]
    v_cvt_pk_bf16_f32 v66, v46, v47
    v_cvt_pk_bf16_f32 v67, v52, v53
    v_pk_add_f32 v[46:47], v[244:245], v[20:21]
    v_pk_add_f32 v[52:53], v[246:247], v[22:23]
    v_pk_fma_f32 v[46:47], v[46:47], v[28:29], v[36:37]
    v_pk_fma_f32 v[52:53], v[52:53], v[30:31], v[38:39]
    v_pk_mul_f32 v[48:49], v[46:47], v[46:47]
    v_pk_mul_f32 v[54:55], v[52:53], v[52:53]
    v_pk_fma_f32 v[48:49], v[48:49], v[40:41], v[42:43]
    v_pk_fma_f32 v[54:55], v[54:55], v[40:41], v[42:43]
    v_pk_mul_f32 v[48:49], v[46:47], v[48:49]
    v_pk_mul_f32 v[54:55], v[52:53], v[54:55]
    v_exp_f32 v50, v48
    v_exp_f32 v51, v49
    v_exp_f32 v56, v54
    v_exp_f32 v57, v55
    v_pk_add_f32 v[50:51], v[50:51], v[44:45]
    v_pk_add_f32 v[56:57], v[56:57], v[44:45]
    v_rcp_f32 v50, v50
    v_rcp_f32 v51, v51
    v_rcp_f32 v56, v56
    v_rcp_f32 v57, v57
    v_pk_mul_f32 v[46:47], v[46:47], v[50:51]
    v_pk_mul_f32 v[52:53], v[52:53], v[56:57]
    v_cvt_pk_bf16_f32 v68, v46, v47
    v_cvt_pk_bf16_f32 v69, v52, v53
    v_cmp_gt_u32 vcc, 7886, v9
    v_add_u32 v2, 114688, v8
    s_nop 0
    v_cndmask_b32 v2, v5, v2, vcc
    buffer_store_dwordx4 v[66:69], v2, s[16:19], 0 offen sc1
    v_pk_add_f32 v[46:47], v[248:249], v[16:17]
    v_pk_add_f32 v[52:53], v[250:251], v[18:19]
    v_pk_fma_f32 v[46:47], v[46:47], v[24:25], v[32:33]
    v_pk_fma_f32 v[52:53], v[52:53], v[26:27], v[34:35]
    v_pk_mul_f32 v[48:49], v[46:47], v[46:47]
    v_pk_mul_f32 v[54:55], v[52:53], v[52:53]
    v_pk_fma_f32 v[48:49], v[48:49], v[40:41], v[42:43]
    v_pk_fma_f32 v[54:55], v[54:55], v[40:41], v[42:43]
    v_pk_mul_f32 v[48:49], v[46:47], v[48:49]
    v_pk_mul_f32 v[54:55], v[52:53], v[54:55]
    v_exp_f32 v50, v48
    v_exp_f32 v51, v49
    v_exp_f32 v56, v54
    v_exp_f32 v57, v55
    v_pk_add_f32 v[50:51], v[50:51], v[44:45]
    v_pk_add_f32 v[56:57], v[56:57], v[44:45]
    v_rcp_f32 v50, v50
    v_rcp_f32 v51, v51
    v_rcp_f32 v56, v56
    v_rcp_f32 v57, v57
    v_pk_mul_f32 v[46:47], v[46:47], v[50:51]
    v_pk_mul_f32 v[52:53], v[52:53], v[56:57]
    v_cvt_pk_bf16_f32 v70, v46, v47
    v_cvt_pk_bf16_f32 v71, v52, v53
    v_pk_add_f32 v[46:47], v[252:253], v[20:21]
    v_pk_add_f32 v[52:53], v[254:255], v[22:23]
    v_pk_fma_f32 v[46:47], v[46:47], v[28:29], v[36:37]
    v_pk_fma_f32 v[52:53], v[52:53], v[30:31], v[38:39]
    v_pk_mul_f32 v[48:49], v[46:47], v[46:47]
    v_pk_mul_f32 v[54:55], v[52:53], v[52:53]
    v_pk_fma_f32 v[48:49], v[48:49], v[40:41], v[42:43]
    v_pk_fma_f32 v[54:55], v[54:55], v[40:41], v[42:43]
    v_pk_mul_f32 v[48:49], v[46:47], v[48:49]
    v_pk_mul_f32 v[54:55], v[52:53], v[54:55]
    v_exp_f32 v50, v48
    v_exp_f32 v51, v49
    v_exp_f32 v56, v54
    v_exp_f32 v57, v55
    v_pk_add_f32 v[50:51], v[50:51], v[44:45]
    v_pk_add_f32 v[56:57], v[56:57], v[44:45]
    v_rcp_f32 v50, v50
    v_rcp_f32 v51, v51
    v_rcp_f32 v56, v56
    v_rcp_f32 v57, v57
    v_pk_mul_f32 v[46:47], v[46:47], v[50:51]
    v_pk_mul_f32 v[52:53], v[52:53], v[56:57]
    v_cvt_pk_bf16_f32 v72, v46, v47
    v_cvt_pk_bf16_f32 v73, v52, v53
    v_cmp_gt_u32 vcc, 7878, v9
    v_add_u32 v2, 122880, v8
    s_nop 0
    v_cndmask_b32 v2, v5, v2, vcc
    buffer_store_dwordx4 v[70:73], v2, s[16:19], 0 offen sc1
    s_waitcnt vmcnt(0)
L_end:
    s_endpgm
.section .rodata,"a"
.p2align 6
.amdhsa_kernel standalone__self_sup_conv_stem_hubert__speech_kernel
  .amdhsa_next_free_vgpr 256
  .amdhsa_next_free_sgpr 102
  .amdhsa_accum_offset 256
  .amdhsa_group_segment_fixed_size 0
  .amdhsa_kernarg_size 64
  .amdhsa_user_sgpr_count 2
  .amdhsa_user_sgpr_kernarg_segment_ptr 1
  .amdhsa_system_sgpr_workgroup_id_x 1
.end_amdhsa_kernel
```
